```python
import torch

def _softmax(x, axis=-1):
    return torch.softmax(x, dim=axis)

def _gelu(x):
    return torch.nn.functional.gelu(x, approximate='tanh')

def _silu(x):
    return torch.nn.functional.silu(x)

def _sigmoid(x):
    return torch.sigmoid(x)

def _layernorm(x, axis=-1, eps=1e-05):
    m = x.mean(dim=axis, keepdim=True)
    v = x.var(dim=axis, keepdim=True, unbiased=False)
    return (x - m) / torch.sqrt(v + eps)

def _scatter_add(tgt, idx, src, axis=0):
    return tgt.clone().index_add_(axis, idx, src)

def _segment_sum(src, seg, n):
    out = torch.zeros((n,) + src.shape[1:], dtype=src.dtype)
    return out.index_add_(0, seg, src)

def _pad(x, pw):
    flat = tuple((v for pair in reversed(pw) for v in pair))
    return torch.nn.functional.pad(x, flat)
kernel_name = 'adaLN_cond__sliding_block_cached__dense_activation_relu__decode'

def setup_inputs():

    _w = lambda a: (lambda t: t.to(torch.bfloat16) if t.is_floating_point() else t)(torch.as_tensor(a))

    def _A_setup():
        B, Sq, D = (2, 1, 1024)
        Hq, Hkv, Sk, Dh = (32, 4, 32768, 128)
        assert Hq % Hkv == 0, (Hq, Hkv)
        return {'x': _w((lambda *s: torch.randn(*s, dtype=torch.bfloat16) * 0.05)(B, Sq, D)), 'k_cache': _w((lambda *s: torch.randn(*s, dtype=torch.bfloat16) * 0.4)(B, Hkv, Sk, Dh)), 'v_cache': _w((lambda *s: torch.randn(*s, dtype=torch.bfloat16) * 0.8)(B, Hkv, Sk, Dh)), 'wq': _w((lambda *s: torch.randn(*s, dtype=torch.bfloat16) * 0.4)(D, Hq * Dh) * D ** (-0.5)), 'wo': _w((lambda *s: torch.randn(*s, dtype=torch.bfloat16) * 0.8)(Hq * Dh, D) * (Hq * Dh) ** (-0.5))}
    _A_in = _A_setup()

    def _B_setup():
        B, S, D, Dff = (2, 1, 1024, 3584)
        return {'x': _w((lambda *s: torch.randn(*s, dtype=torch.bfloat16) * 0.05)(B, S, D)), 'w1': _w((lambda *s: torch.randn(*s, dtype=torch.bfloat16) * 0.05)(D, Dff)), 'w2': _w((lambda *s: torch.randn(*s, dtype=torch.bfloat16) * 0.05)(Dff, D))}
    _B_in = _B_setup()
    return {'A_x': _A_in['x'], 'A_k_cache': _A_in['k_cache'], 'A_v_cache': _A_in['v_cache'], 'A_wq': _A_in['wq'], 'A_wo': _A_in['wo'], 'B_x': _B_in['x'], 'B_w1': _B_in['w1'], 'B_w2': _B_in['w2'], 'c': _w((lambda *s: torch.randn(*s, dtype=torch.bfloat16) * 0.4)(2, 1024) * 8.0), 'w_mod': _w((lambda *s: torch.randn(*s, dtype=torch.bfloat16) * 0.4)(1024, 6 * 1024) * 1024 ** (-0.5) * 8.0)}

def reference(A_x, A_k_cache, A_v_cache, A_wq, A_wo, B_x, B_w1, B_w2, c, w_mod):

    def _A_ref(x, k_cache, v_cache, wq, wo):
        B, Sq, D = x.shape
        Hq, Dh = (32, 128)
        Hkv, Sk = (k_cache.shape[1], k_cache.shape[2])
        W = min(4096, max(256, Sk // 4))
        rep = Hq // Hkv
        q = (lambda x, *d: x.permute(*d))((x @ wq).reshape(B, Sq, Hq, Dh), 0, 2, 1, 3)
        k = (lambda x, n, axis: torch.repeat_interleave(x, n, dim=axis))(k_cache[:, :, Sk - W:, :], rep, axis=1)
        v = (lambda x, n, axis: torch.repeat_interleave(x, n, dim=axis))(v_cache[:, :, Sk - W:, :], rep, axis=1)
        scores = torch.einsum('bhqd,bhkd->bhqk', q, k) * Dh ** (-0.5)
        p = _softmax(scores, axis=-1)
        o = torch.einsum('bhqk,bhkd->bhqd', p, v)
        return (lambda x, *d: x.permute(*d))(o, 0, 2, 1, 3).reshape(B, Sq, Hq * Dh) @ wo

    def _B_ref(x, w1, w2):
        h = torch.einsum('bsd,df->bsf', x, w1)
        zero = torch.zeros_like(h)
        h = torch.maximum(h, zero)
        return torch.einsum('bsf,fd->bsd', h, w2)
    x = A_x
    mod = (_silu(c) @ w_mod).reshape(c.shape[0], 6, 1, -1)
    sa, ca, ga, sb, cb, gb = (mod[:, 0].clone(), mod[:, 1].clone(), mod[:, 2].clone(), mod[:, 3].clone(), mod[:, 4].clone(), mod[:, 5].clone())
    h = _layernorm(x, axis=-1) * (1 + ca) + sa
    x = x + ga * _A_ref(h, A_k_cache, A_v_cache, A_wq, A_wo)
    h = _layernorm(x, axis=-1) * (1 + cb) + sb
    x = x + gb * _B_ref(h, B_w1, B_w2)
    return x
```

```asm
; @launch grid=(256,1,1) block=(768,1,1) lds=163840
.amdgcn_target "amdgcn-amd-amdhsa--gfx950"
.text
.globl adaLN_cond__sliding_block_cached__dense_activation_relu__decode_kernel
.p2align 8
.type adaLN_cond__sliding_block_cached__dense_activation_relu__decode_kernel,@function
adaLN_cond__sliding_block_cached__dense_activation_relu__decode_kernel:
    s_load_dwordx8 s[20:27], s[0:1], 64
    s_load_dwordx16 s[4:19], s[0:1], 0
    s_load_dwordx2 s[28:29], s[0:1], 96
    s_cmp_ge_u32 s2, 256
    s_cbranch_scc1 L_end
    v_lshrrev_b32 v2, 6, v0
    v_and_b32 v1, 63, v0
    v_readfirstlane_b32 s93, v2
    v_lshrrev_b32 v2, 4, v1
    v_and_b32 v3, 15, v1
    s_and_b32 s30, s2, 7
    s_lshr_b32 s31, s2, 3
    s_mov_b32 s34, 400000
    v_mov_b32 v8, 147456
    s_mov_b32 s36, 0x01010101
    s_mov_b32 s37, 0x01010101
    v_lshrrev_b32 v144, 5, v1
    s_and_b32 s42, s93, 14
    s_cmp_lg_u32 s42, 4
    s_cbranch_scc1 L_nopf
    s_getpc_b64 s[38:39]
L_pc:
    v_and_b32 v145, 127, v0
    v_lshlrev_b32 v145, 7, v145
    v_min_u32 v145, L_codeend-L_pc-4, v145
    global_load_dword v136, v145, s[38:39]
L_nopf:
    s_cmp_ge_u32 s93, 4
    s_cbranch_scc1 L_comp
    s_setprio 3
    s_lshl_b32 s42, s93, 2
    v_lshl_add_u32 v145, v144, 1, s42
    v_xor_b32 v16, v3, v145
    v_lshlrev_b32 v16, 4, v16
    v_add_u32 v20, s42, v8
    v_and_b32 v152, 1, v2
    v_mul_u32_u24 v18, 12288, v144
    v_lshl_add_u32 v18, v152, 11, v18
    v_add_u32 v18, v18, v16
    v_lshl_add_u32 v16, v152, 8, v16
    s_and_b32 s42, s93, 1
    s_lshl_b32 s42, s42, 3
    v_lshl_add_u32 v145, v2, 1, s42
    v_xor_b32 v17, v3, v145
    v_lshlrev_b32 v17, 4, v17
    s_mul_i32 s44, s31, 393216
    s_mul_i32 s45, s93, 24576
    s_add_u32 s44, s44, s45
    s_lshl_b32 s45, s30, 8
    s_add_u32 s44, s44, s45
    s_lshl_b32 s3, s93, 10
    s_mul_i32 s55, s31, 0
    s_lshl_b32 s45, s30, 13
    s_add_u32 s55, s55, s45
    s_mov_b32 s59, 0x20000
    s_waitcnt lgkmcnt(0)
    s_add_u32 s38, s22, s44
    s_addc_u32 s39, s23, 0
    s_add_u32 m0, s3, 131072
    s_nop 0
    global_load_lds_dwordx4 v18, s[38:39] nt
    s_add_u32 s38, s38, 98304
    s_addc_u32 s39, s39, 0
    s_add_u32 m0, s3, 135168
    s_nop 0
    global_load_lds_dwordx4 v18, s[38:39] nt
    s_add_u32 s38, s38, 98304
    s_addc_u32 s39, s39, 0
    s_add_u32 m0, s3, 139264
    s_nop 0
    global_load_lds_dwordx4 v18, s[38:39] nt
    s_add_u32 s38, s38, 98304
    s_addc_u32 s39, s39, 0
    s_add_u32 m0, s3, 143360
    s_nop 0
    global_load_lds_dwordx4 v18, s[38:39] nt
    s_load_dword s50, s[28:29], 0
    s_and_b32 s14, s31, 15
    s_cmp_ge_u32 s2, 128
    s_cbranch_scc1 L_ldB
    s_lshl_b32 s42, s93, 2
    v_add_u32 v145, s42, v2
    v_xor_b32 v18, v3, v145
    v_lshlrev_b32 v18, 4, v18
    v_lshl_add_u32 v18, v2, 8, v18
    s_lshl_b32 s42, s30, 23
    s_mul_i32 s45, s14, 0
    s_add_u32 s42, s42, s45
    s_lshl_b32 s45, s93, 10
    s_add_u32 s42, s42, s45
    s_add_u32 s42, s42, 7340032
    s_add_u32 s56, s6, s42
    s_addc_u32 s57, s7, 0
    s_sub_u32 s58, 67108864, s42
    s_add_u32 s54, s3, 0
    s_mov_b32 s46, s55
    s_lshl_b32 s43, s14, 12
    s_lshl_b32 s46, s14, 13
    s_lshl_b32 s45, s30, 12
    s_add_u32 s46, s46, s45
    s_barrier
    s_mov_b32 s53, 5
    s_add_u32 s46, s46, 0x1000
    s_and_b32 s46, s46, 0xf000
    s_add_u32 m0, s46, s54
    s_mul_i32 s52, s46, 16
    s_add_u32 s45, s46, s43
    s_and_b32 s45, s45, 0xf000
    s_add_u32 s52, s52, s45
    s_waitcnt vmcnt(4)
    buffer_load_dwordx4 v18, s[56:59], s52 offen nt lds
    s_mov_b32 s47, 1
Ld_1:
    s_add_u32 s46, s46, 0x1000
    s_and_b32 s46, s46, 0xf000
    s_add_u32 m0, s46, s54
    s_mul_i32 s52, s46, 16
    s_add_u32 s45, s46, s43
    s_and_b32 s45, s45, 0xf000
    s_add_u32 s52, s52, s45
    s_waitcnt vmcnt(4)
    buffer_load_dwordx4 v18, s[56:59], s52 offen nt lds
    s_add_u32 s46, s46, 0x1000
    s_and_b32 s46, s46, 0xf000
    s_add_u32 m0, s46, s54
    s_mul_i32 s52, s46, 16
    s_add_u32 s45, s46, s43
    s_and_b32 s45, s45, 0xf000
    s_add_u32 s52, s52, s45
    s_waitcnt vmcnt(4)
    buffer_load_dwordx4 v18, s[56:59], s52 offen nt lds
    s_sub_u32 s47, s47, 1
    s_cbranch_scc0 Ld_1
    v_mov_b32 v19, 1
    ds_write_b32 v20, v19 offset:0
    s_add_u32 s46, s46, 0x1000
    s_and_b32 s46, s46, 0xf000
    s_add_u32 m0, s46, s54
    s_mul_i32 s52, s46, 16
    s_add_u32 s45, s46, s43
    s_and_b32 s45, s45, 0xf000
    s_add_u32 s52, s52, s45
    s_waitcnt vmcnt(4)
    buffer_load_dwordx4 v18, s[56:59], s52 offen nt lds
    s_mov_b32 s47, 4
Ld_2:
    s_add_u32 s46, s46, 0x1000
    s_and_b32 s46, s46, 0xf000
    s_add_u32 m0, s46, s54
    s_mul_i32 s52, s46, 16
    s_add_u32 s45, s46, s43
    s_and_b32 s45, s45, 0xf000
    s_add_u32 s52, s52, s45
    s_waitcnt vmcnt(4)
    buffer_load_dwordx4 v18, s[56:59], s52 offen nt lds
    s_add_u32 s46, s46, 0x1000
    s_and_b32 s46, s46, 0xf000
    s_add_u32 m0, s46, s54
    s_mul_i32 s52, s46, 16
    s_add_u32 s45, s46, s43
    s_and_b32 s45, s45, 0xf000
    s_add_u32 s52, s52, s45
    s_waitcnt vmcnt(4)
    buffer_load_dwordx4 v18, s[56:59], s52 offen nt lds
    s_sub_u32 s47, s47, 1
    s_cbranch_scc0 Ld_2
    v_mul_u32_u24 v18, 256, v2
    v_add_u32 v18, v18, v17
    s_add_u32 s56, s8, s42
    s_addc_u32 s57, s9, 0
    s_add_u32 s54, s3, 65536
    s_mov_b32 s53, 9
    s_add_u32 s46, s46, 0x1000
    s_and_b32 s46, s46, 0xf000
    s_add_u32 m0, s46, s54
    s_mul_i32 s52, s46, 16
    s_add_u32 s45, s46, s43
    s_and_b32 s45, s45, 0xf000
    s_add_u32 s52, s52, s45
    s_waitcnt vmcnt(8)
    buffer_load_dwordx4 v18, s[56:59], s52 offen nt lds
    s_mov_b32 s47, 3
Ld_3:
    s_add_u32 s46, s46, 0x1000
    s_and_b32 s46, s46, 0xf000
    s_add_u32 m0, s46, s54
    s_mul_i32 s52, s46, 16
    s_add_u32 s45, s46, s43
    s_and_b32 s45, s45, 0xf000
    s_add_u32 s52, s52, s45
    s_waitcnt vmcnt(8)
    buffer_load_dwordx4 v18, s[56:59], s52 offen nt lds
    s_add_u32 s46, s46, 0x1000
    s_and_b32 s46, s46, 0xf000
    s_add_u32 m0, s46, s54
    s_mul_i32 s52, s46, 16
    s_add_u32 s45, s46, s43
    s_and_b32 s45, s45, 0xf000
    s_add_u32 s52, s52, s45
    s_waitcnt vmcnt(8)
    buffer_load_dwordx4 v18, s[56:59], s52 offen nt lds
    s_sub_u32 s47, s47, 1
    s_cbranch_scc0 Ld_3
    v_mov_b32 v19, 2
    ds_write_b32 v20, v19 offset:0
    s_add_u32 s46, s46, 0x1000
    s_and_b32 s46, s46, 0xf000
    s_add_u32 m0, s46, s54
    s_mul_i32 s52, s46, 16
    s_add_u32 s45, s46, s43
    s_and_b32 s45, s45, 0xf000
    s_add_u32 s52, s52, s45
    s_waitcnt vmcnt(8)
    buffer_load_dwordx4 v18, s[56:59], s52 offen nt lds
    s_mov_b32 s47, 2
Ld_4:
    s_add_u32 s46, s46, 0x1000
    s_and_b32 s46, s46, 0xf000
    s_add_u32 m0, s46, s54
    s_mul_i32 s52, s46, 16
    s_add_u32 s45, s46, s43
    s_and_b32 s45, s45, 0xf000
    s_add_u32 s52, s52, s45
    s_waitcnt vmcnt(8)
    buffer_load_dwordx4 v18, s[56:59], s52 offen nt lds
    s_add_u32 s46, s46, 0x1000
    s_and_b32 s46, s46, 0xf000
    s_add_u32 m0, s46, s54
    s_mul_i32 s52, s46, 16
    s_add_u32 s45, s46, s43
    s_and_b32 s45, s45, 0xf000
    s_add_u32 s52, s52, s45
    s_waitcnt vmcnt(8)
    buffer_load_dwordx4 v18, s[56:59], s52 offen nt lds
    s_sub_u32 s47, s47, 1
    s_cbranch_scc0 Ld_4
    s_and_b32 s94, s30, 3
    s_lshr_b32 s96, s30, 2
    s_and_b32 s95, s14, 7
    s_lshr_b32 s42, s14, 3
    s_lshl_b32 s42, s42, 1
    s_add_u32 s96, s96, s42
    s_lshl_b32 s97, s96, 8
    s_add_u32 s97, s97, 128
    s_add_u32 s96, s96, 4
    v_mul_u32_u24 v18, 12288, v2
    v_add_u32 v18, v18, v17
    s_mul_i32 s42, s97, 12288
    s_mul_i32 s45, s93, 49152
    s_add_u32 s42, s42, s45
    s_lshl_b32 s45, s94, 11
    s_add_u32 s42, s42, s45
    s_lshl_b32 s45, s95, 8
    s_add_u32 s42, s42, s45
    s_add_u32 s42, s42, 4096
    s_add_u32 s56, s22, s42
    s_addc_u32 s57, s23, 0
    s_sub_u32 s58, 12582912, s42
    s_add_u32 s54, s3, 0
    s_mov_b32 s46, 0xf000
    s_waitcnt lgkmcnt(0)
    s_add_u32 s32, s50, 0x9e5
    s_and_b32 s32, s32, 0xfff
    s_max_u32 s32, s32, 1
    s_mul_i32 s35, s32, 0x00100101
    s_xor_b32 s35, s35, 0x5a5a0000
    v_mov_b32 v5, s35
    v_mov_b32 v21, 0
    s_lshl_b32 s42, s30, 11
    s_lshl_b32 s45, s14, 7
    s_add_u32 s42, s42, s45
    s_add_u32 s42, s42, 2150400
    s_add_u32 s98, s28, s42
    s_addc_u32 s99, s29, 0
    s_lshl_b32 s42, s30, 11
    s_add_u32 s42, s42, 2166784
    s_add_u32 s100, s28, s42
    s_addc_u32 s101, s29, 0
    v_lshrrev_b32 v24, 2, v1
    v_lshlrev_b32 v24, 7, v24
    v_lshlrev_b32 v25, 2, v1
    s_waitcnt vmcnt(1)
    s_barrier
    s_waitcnt vmcnt(0)
    s_barrier
    s_add_u32 s46, s46, 0x1000
    s_and_b32 s46, s46, 0xf000
    s_add_u32 m0, s46, s54
    s_mul_i32 s52, s46, 48
    buffer_load_dwordx4 v18, s[56:59], s52 offen nt lds
    s_add_u32 s46, s46, 0x1000
    s_and_b32 s46, s46, 0xf000
    s_add_u32 m0, s46, s54
    s_mul_i32 s52, s46, 48
    buffer_load_dwordx4 v18, s[56:59], s52 offen nt lds
    s_add_u32 s46, s46, 0x1000
    s_and_b32 s46, s46, 0xf000
    s_add_u32 m0, s46, s54
    s_mul_i32 s52, s46, 48
    buffer_load_dwordx4 v18, s[56:59], s52 offen nt lds
    s_barrier
    s_add_u32 s46, s46, 0x1000
    s_and_b32 s46, s46, 0xf000
    s_add_u32 m0, s46, s54
    s_mul_i32 s52, s46, 48
    buffer_load_dwordx4 v18, s[56:59], s52 offen nt lds
    s_add_u32 s46, s46, 0x1000
    s_and_b32 s46, s46, 0xf000
    s_add_u32 m0, s46, s54
    s_mul_i32 s52, s46, 48
    buffer_load_dwordx4 v18, s[56:59], s52 offen nt lds
    s_add_u32 s46, s46, 0x1000
    s_and_b32 s46, s46, 0xf000
    s_add_u32 m0, s46, s54
    s_mul_i32 s52, s46, 48
    buffer_load_dwordx4 v18, s[56:59], s52 offen nt lds
    s_barrier
    s_barrier
    s_barrier
    s_add_u32 s46, s46, 0x1000
    s_and_b32 s46, s46, 0xf000
    s_add_u32 m0, s46, s54
    s_mul_i32 s52, s46, 48
    s_waitcnt vmcnt(6)
    buffer_load_dwordx4 v18, s[56:59], s52 offen nt lds
    s_add_u32 s46, s46, 0x1000
    s_and_b32 s46, s46, 0xf000
    s_add_u32 m0, s46, s54
    s_mul_i32 s52, s46, 48
    s_waitcnt vmcnt(6)
    buffer_load_dwordx4 v18, s[56:59], s52 offen nt lds
    s_cmp_ge_u32 s14, 14
    s_cbranch_scc1 L_mdone
    v_mul_u32_u24 v18, 7168, v144
    v_add_u32 v18, v18, v16
    s_mul_i32 s42, s30, 114688
    s_mul_i32 s45, s93, 14336
    s_add_u32 s42, s42, s45
    s_lshl_b32 s45, s14, 9
    s_add_u32 s42, s42, s45
    s_add_u32 s56, s16, s42
    s_addc_u32 s57, s17, 0
    s_sub_u32 s58, 7340032, s42
    s_add_u32 s54, s3, 65536
    s_mov_b32 s46, s55
    s_mov_b32 s53, 7
    s_add_u32 s46, s46, 0x1000
    s_and_b32 s46, s46, 0xf000
    s_add_u32 m0, s46, s54
    s_and_b32 s45, s46, 0xe000
    s_mul_i32 s45, s45, 98
    s_mul_i32 s52, s46, 14
    s_add_u32 s52, s52, s45
    s_waitcnt vmcnt(6)
    buffer_load_dwordx4 v18, s[56:59], s52 offen nt lds
    s_mov_b32 s47, 2
Ld_5:
    s_add_u32 s46, s46, 0x1000
    s_and_b32 s46, s46, 0xf000
    s_add_u32 m0, s46, s54
    s_and_b32 s45, s46, 0xe000
    s_mul_i32 s45, s45, 98
    s_mul_i32 s52, s46, 14
    s_add_u32 s52, s52, s45
    s_waitcnt vmcnt(6)
    buffer_load_dwordx4 v18, s[56:59], s52 offen nt lds
    s_add_u32 s46, s46, 0x1000
    s_and_b32 s46, s46, 0xf000
    s_add_u32 m0, s46, s54
    s_and_b32 s45, s46, 0xe000
    s_mul_i32 s45, s45, 98
    s_mul_i32 s52, s46, 14
    s_add_u32 s52, s52, s45
    s_waitcnt vmcnt(6)
    buffer_load_dwordx4 v18, s[56:59], s52 offen nt lds
    s_sub_u32 s47, s47, 1
    s_cbranch_scc0 Ld_5
    v_mov_b32 v19, 3
    ds_write_b32 v20, v19 offset:0
    s_add_u32 s46, s46, 0x1000
    s_and_b32 s46, s46, 0xf000
    s_add_u32 m0, s46, s54
    s_and_b32 s45, s46, 0xe000
    s_mul_i32 s45, s45, 98
    s_mul_i32 s52, s46, 14
    s_add_u32 s52, s52, s45
    s_waitcnt vmcnt(6)
    buffer_load_dwordx4 v18, s[56:59], s52 offen nt lds
    s_mov_b32 s47, 3
Ld_6:
    s_add_u32 s46, s46, 0x1000
    s_and_b32 s46, s46, 0xf000
    s_add_u32 m0, s46, s54
    s_and_b32 s45, s46, 0xe000
    s_mul_i32 s45, s45, 98
    s_mul_i32 s52, s46, 14
    s_add_u32 s52, s52, s45
    s_waitcnt vmcnt(6)
    buffer_load_dwordx4 v18, s[56:59], s52 offen nt lds
    s_add_u32 s46, s46, 0x1000
    s_and_b32 s46, s46, 0xf000
    s_add_u32 m0, s46, s54
    s_and_b32 s45, s46, 0xe000
    s_mul_i32 s45, s45, 98
    s_mul_i32 s52, s46, 14
    s_add_u32 s52, s52, s45
    s_waitcnt vmcnt(6)
    buffer_load_dwordx4 v18, s[56:59], s52 offen nt lds
    s_sub_u32 s47, s47, 1
    s_cbranch_scc0 Ld_6
    s_lshl_b32 s42, s14, 10
    s_lshl_b32 s45, s30, 7
    s_add_u32 s42, s42, s45
    s_add_u32 s42, s42, 2134016
    s_add_u32 s38, s28, s42
    s_addc_u32 s39, s29, 0
    v_lshl_add_u32 v18, v1, 3, v8
    v_lshlrev_b32 v19, 6, v144
    v_lshl_add_u32 v19, v3, 4, v19
    v_mov_b32 v117, s35
    v_mov_b32 v119, s35
    s_waitcnt vmcnt(2)
    s_barrier
    s_waitcnt vmcnt(0)
    s_barrier
    s_barrier
    s_cmp_eq_u32 s93, 0
    s_cbranch_scc1 L_st
    s_cmp_lg_u32 s93, 1
    s_cbranch_scc1 Hs_7
    s_add_u32 s38, s98, 32768
    s_addc_u32 s39, s99, 0
    s_mov_b32 exec_lo, -1
    s_mov_b32 exec_hi, 0
    global_store_dword v25, v5, s[38:39]
    s_mov_b64 exec, -1
Hs_7:
    s_cmp_lg_u32 s93, 2
    s_cbranch_scc1 L_fin
    s_add_u32 s38, s98, 16384
    s_addc_u32 s39, s99, 0
    s_mov_b32 exec_hi, 0
    global_store_dword v25, v5, s[38:39] sc1
    s_waitcnt vmcnt(0)
    s_mov_b32 exec_lo, -1
    s_mov_b32 exec_hi, 0
    global_store_dword v25, v5, s[98:99]
    s_mov_b64 exec, -1
    s_branch L_fin
L_st:
    ds_read_b64 v[112:113], v18 offset:384
    s_waitcnt lgkmcnt(0)
    v_add_f32_dpp v112, v112, v112 quad_perm:[1,0,3,2] row_mask:0xf bank_mask:0xf
    v_add_f32_dpp v113, v113, v113 quad_perm:[1,0,3,2] row_mask:0xf bank_mask:0xf
    s_nop 0
    v_add_f32_dpp v112, v112, v112 quad_perm:[2,3,0,1] row_mask:0xf bank_mask:0xf
    v_add_f32_dpp v113, v113, v113 quad_perm:[2,3,0,1] row_mask:0xf bank_mask:0xf
    s_nop 0
    v_add_f32_dpp v112, v112, v112 row_half_mirror row_mask:0xf bank_mask:0xf
    v_add_f32_dpp v113, v113, v113 row_half_mirror row_mask:0xf bank_mask:0xf
    s_nop 0
    v_add_f32_dpp v112, v112, v112 row_mirror row_mask:0xf bank_mask:0xf
    v_add_f32_dpp v113, v113, v113 row_mirror row_mask:0xf bank_mask:0xf
    v_mov_b32 v114, v112
    v_mov_b32 v115, v113
    s_nop 0
    v_permlane16_swap_b32 v112, v114
    v_permlane16_swap_b32 v113, v115
    v_add_f32 v116, v112, v114
    v_add_f32 v118, v113, v115
    s_mov_b32 exec_lo, 15
    s_mov_b32 exec_hi, 15
    global_store_dwordx4 v19, v[116:119], s[38:39] sc1
    s_mov_b64 exec, -1
    s_branch L_fin
L_mdone:
    s_waitcnt vmcnt(0)
    v_mov_b32 v19, 3
    ds_write_b32 v20, v19 offset:0
    s_branch L_fin
L_ldB:
    v_mul_u32_u24 v18, 8192, v144
    v_add_u32 v18, v18, v16
    s_lshl_b32 s42, s30, 20
    s_lshl_b32 s45, s93, 14
    s_add_u32 s42, s42, s45
    s_lshl_b32 s45, s14, 9
    s_add_u32 s42, s42, s45
    s_add_u32 s56, s10, s42
    s_addc_u32 s57, s11, 0
    s_sub_u32 s58, 8388608, s42
    s_add_u32 s54, s3, 0
    s_mov_b32 s46, s55
    s_barrier
    s_mov_b32 s53, 7
    s_add_u32 s46, s46, 0x1000
    s_and_b32 s46, s46, 0xf000
    s_add_u32 m0, s46, s54
    s_mul_i32 s52, s46, 16
    s_waitcnt vmcnt(6)
    buffer_load_dwordx4 v18, s[56:59], s52 offen nt lds
    s_mov_b32 s47, 2
Ld_8:
    s_add_u32 s46, s46, 0x1000
    s_and_b32 s46, s46, 0xf000
    s_add_u32 m0, s46, s54
    s_mul_i32 s52, s46, 16
    s_waitcnt vmcnt(6)
    buffer_load_dwordx4 v18, s[56:59], s52 offen nt lds
    s_add_u32 s46, s46, 0x1000
    s_and_b32 s46, s46, 0xf000
    s_add_u32 m0, s46, s54
    s_mul_i32 s52, s46, 16
    s_waitcnt vmcnt(6)
    buffer_load_dwordx4 v18, s[56:59], s52 offen nt lds
    s_sub_u32 s47, s47, 1
    s_cbranch_scc0 Ld_8
    v_mov_b32 v19, 1
    ds_write_b32 v20, v19 offset:0
    s_add_u32 s46, s46, 0x1000
    s_and_b32 s46, s46, 0xf000
    s_add_u32 m0, s46, s54
    s_mul_i32 s52, s46, 16
    s_waitcnt vmcnt(6)
    buffer_load_dwordx4 v18, s[56:59], s52 offen nt lds
    s_mov_b32 s47, 3
Ld_9:
    s_add_u32 s46, s46, 0x1000
    s_and_b32 s46, s46, 0xf000
    s_add_u32 m0, s46, s54
    s_mul_i32 s52, s46, 16
    s_waitcnt vmcnt(6)
    buffer_load_dwordx4 v18, s[56:59], s52 offen nt lds
    s_add_u32 s46, s46, 0x1000
    s_and_b32 s46, s46, 0xf000
    s_add_u32 m0, s46, s54
    s_mul_i32 s52, s46, 16
    s_waitcnt vmcnt(6)
    buffer_load_dwordx4 v18, s[56:59], s52 offen nt lds
    s_sub_u32 s47, s47, 1
    s_cbranch_scc0 Ld_9
    s_and_b32 s94, s30, 3
    s_lshr_b32 s96, s30, 2
    s_lshr_b32 s95, s14, 1
    s_xor_b32 s95, s95, 1
    s_and_b32 s42, s14, 1
    s_lshl_b32 s42, s42, 1
    s_add_u32 s96, s96, s42
    s_lshl_b32 s97, s96, 8
    v_mul_u32_u24 v18, 12288, v2
    v_add_u32 v18, v18, v17
    s_mul_i32 s42, s97, 12288
    s_mul_i32 s45, s93, 49152
    s_add_u32 s42, s42, s45
    s_lshl_b32 s45, s94, 11
    s_add_u32 s42, s42, s45
    s_lshl_b32 s45, s95, 8
    s_add_u32 s42, s42, s45
    s_add_u32 s42, s42, 4096
    s_add_u32 s56, s22, s42
    s_addc_u32 s57, s23, 0
    s_sub_u32 s58, 12582912, s42
    s_add_u32 s54, s3, 65536
    s_mov_b32 s46, 0xf000
    s_waitcnt lgkmcnt(0)
    s_add_u32 s32, s50, 0x9e5
    s_and_b32 s32, s32, 0xfff
    s_max_u32 s32, s32, 1
    s_mul_i32 s35, s32, 0x00100101
    s_xor_b32 s35, s35, 0x5a5a0000
    v_mov_b32 v5, s35
    v_mov_b32 v21, 0
    s_lshl_b32 s42, s30, 11
    s_lshl_b32 s45, s14, 7
    s_add_u32 s42, s42, s45
    s_add_u32 s42, s42, 2150400
    s_add_u32 s98, s28, s42
    s_addc_u32 s99, s29, 0
    s_lshl_b32 s42, s30, 11
    s_add_u32 s42, s42, 2166784
    s_add_u32 s100, s28, s42
    s_addc_u32 s101, s29, 0
    v_lshrrev_b32 v24, 2, v1
    v_lshlrev_b32 v24, 7, v24
    v_lshlrev_b32 v25, 2, v1
    s_waitcnt vmcnt(5)
    s_barrier
    s_waitcnt vmcnt(0)
    s_barrier
    s_barrier
    s_barrier
    s_mov_b32 s47, 3
Ld_10:
    s_add_u32 s46, s46, 0x1000
    s_and_b32 s46, s46, 0xf000
    s_add_u32 m0, s46, s54
    s_mul_i32 s52, s46, 48
    s_waitcnt vmcnt(6)
    buffer_load_dwordx4 v18, s[56:59], s52 offen nt lds
    s_add_u32 s46, s46, 0x1000
    s_and_b32 s46, s46, 0xf000
    s_add_u32 m0, s46, s54
    s_mul_i32 s52, s46, 48
    s_waitcnt vmcnt(6)
    buffer_load_dwordx4 v18, s[56:59], s52 offen nt lds
    s_sub_u32 s47, s47, 1
    s_cbranch_scc0 Ld_10
    v_mul_u32_u24 v18, 2048, v2
    v_add_u32 v18, v18, v17
    s_and_b32 s43, s14, 1
    s_lshr_b32 s44, s14, 1
    s_lshl_b32 s42, s30, 17
    s_lshl_b32 s45, s43, 16
    s_add_u32 s42, s42, s45
    s_lshl_b32 s45, s93, 13
    s_add_u32 s42, s42, s45
    s_lshl_b32 s45, s44, 8
    s_add_u32 s42, s42, s45
    s_add_u32 s56, s12, s42
    s_addc_u32 s57, s13, 0
    s_sub_u32 s58, 8388608, s42
    s_add_u32 s54, s3, 0
    s_mov_b32 s46, s55
    s_mov_b32 s53, 6
    s_mov_b32 s47, 2
Ld_11:
    s_add_u32 s46, s46, 0x1000
    s_and_b32 s46, s46, 0xf000
    s_add_u32 m0, s46, s54
    s_and_b32 s45, s46, 0xe000
    s_mul_i32 s45, s45, 120
    s_mul_i32 s52, s46, 8
    s_add_u32 s52, s52, s45
    s_waitcnt vmcnt(5)
    buffer_load_dwordx4 v18, s[56:59], s52 offen nt lds
    s_add_u32 s46, s46, 0x1000
    s_and_b32 s46, s46, 0xf000
    s_add_u32 m0, s46, s54
    s_and_b32 s45, s46, 0xe000
    s_mul_i32 s45, s45, 120
    s_mul_i32 s52, s46, 8
    s_add_u32 s52, s52, s45
    s_waitcnt vmcnt(5)
    buffer_load_dwordx4 v18, s[56:59], s52 offen nt lds
    s_sub_u32 s47, s47, 1
    s_cbranch_scc0 Ld_11
    v_mov_b32 v19, 3
    ds_write_b32 v20, v19 offset:0
    s_mov_b32 s47, 4
Ld_12:
    s_add_u32 s46, s46, 0x1000
    s_and_b32 s46, s46, 0xf000
    s_add_u32 m0, s46, s54
    s_and_b32 s45, s46, 0xe000
    s_mul_i32 s45, s45, 120
    s_mul_i32 s52, s46, 8
    s_add_u32 s52, s52, s45
    s_waitcnt vmcnt(5)
    buffer_load_dwordx4 v18, s[56:59], s52 offen nt lds
    s_add_u32 s46, s46, 0x1000
    s_and_b32 s46, s46, 0xf000
    s_add_u32 m0, s46, s54
    s_and_b32 s45, s46, 0xe000
    s_mul_i32 s45, s45, 120
    s_mul_i32 s52, s46, 8
    s_add_u32 s52, s52, s45
    s_waitcnt vmcnt(5)
    buffer_load_dwordx4 v18, s[56:59], s52 offen nt lds
    s_sub_u32 s47, s47, 1
    s_cbranch_scc0 Ld_12
    s_min_u32 s43, s14, 13
    s_lshl_b32 s42, s43, 15
    s_lshl_b32 s45, s93, 13
    s_add_u32 s42, s42, s45
    s_lshl_b32 s45, s30, 8
    s_add_u32 s42, s42, s45
    s_add_u32 s56, s18, s42
    s_addc_u32 s57, s19, 0
    s_sub_u32 s58, 7340032, s42
    s_add_u32 s54, s3, 65536
    s_mov_b32 s46, s55
    s_waitcnt vmcnt(0)
    s_barrier
    s_barrier
    s_barrier
    s_barrier
    s_cmp_ge_u32 s14, 14
    s_cbranch_scc1 L_fin
    s_lshl_b32 s42, s30, 11
    s_add_u32 s42, s42, 2150400
    s_add_u32 s98, s28, s42
    s_addc_u32 s99, s29, 0
    v_min_u32 v21, 384, v24
    s_mov_b32 s47, 5
Ld_13:
    s_add_u32 s46, s46, 0x1000
    s_and_b32 s46, s46, 0xf000
    s_add_u32 m0, s46, s54
    s_mul_i32 s52, s46, 112
    s_waitcnt vmcnt(8)
    buffer_load_dwordx4 v18, s[56:59], s52 offen nt lds
    s_add_u32 s46, s46, 0x1000
    s_and_b32 s46, s46, 0xf000
    s_add_u32 m0, s46, s54
    s_mul_i32 s52, s46, 112
    s_waitcnt vmcnt(8)
    buffer_load_dwordx4 v18, s[56:59], s52 offen nt lds
    s_sub_u32 s47, s47, 1
    s_cbranch_scc0 Ld_13
    global_load_dword v22, v21, s[98:99] sc1
    s_mov_b32 s47, 1
Ld_14:
    s_add_u32 s46, s46, 0x1000
    s_and_b32 s46, s46, 0xf000
    s_add_u32 m0, s46, s54
    s_mul_i32 s52, s46, 112
    s_waitcnt vmcnt(8)
    buffer_load_dwordx4 v18, s[56:59], s52 offen nt lds
    s_add_u32 s46, s46, 0x1000
    s_and_b32 s46, s46, 0xf000
    s_add_u32 m0, s46, s54
    s_mul_i32 s52, s46, 112
    s_waitcnt vmcnt(8)
    buffer_load_dwordx4 v18, s[56:59], s52 offen nt lds
    s_sub_u32 s47, s47, 1
    s_cbranch_scc0 Ld_14
    s_cmp_lg_u32 s93, 0
    s_cbranch_scc1 L_h5d
    global_load_dword v23, v21, s[98:99] sc1
    s_mov_b32 s47, 40
    s_waitcnt vmcnt(5)
    v_cmp_ne_u32 vcc, v22, v5
    s_cbranch_vccz L_h5d
    s_waitcnt vmcnt(0)
    v_cmp_ne_u32 vcc, v23, v5
    s_cbranch_vccz L_h5d
L_h5:
    global_load_dword v19, v21, s[98:99] sc1
    s_waitcnt vmcnt(0)
    v_cmp_ne_u32 vcc, v19, v5
    s_cbranch_vccz L_h5o
    s_sub_u32 s47, s47, 1
    s_cbranch_scc0 L_h5
L_h5o:
L_h5d:
    s_barrier
    s_waitcnt vmcnt(0)
    s_barrier
    s_barrier
    s_branch L_fin
L_comp:
    s_sub_u32 s3, s93, 4
    v_lshlrev_b32 v145, 11, v144
    v_and_b32 v146, 31, v1
    v_lshl_add_u32 v147, v146, 1, v145
    s_lshl_b32 s42, s31, 6
    v_add_u32 v148, s42, v147
    v_lshl_add_u32 v149, v146, 3, v145
    s_lshl_b32 s42, s3, 8
    v_add_u32 v149, s42, v149
    s_lshl_b32 s43, s30, 8
    s_lshl_b32 s45, s3, 5
    s_add_u32 s43, s43, s45
    v_and_b32 v150, 1, v2
    v_lshlrev_b32 v150, 11, v150
    v_lshl_add_u32 v150, v3, 1, v150
    v_add_u32 v150, s43, v150
    v_mov_b32 v152, 0
    v_lshl_add_u32 v153, v146, 2, v8
    ds_write_b32 v153, v152
    s_waitcnt lgkmcnt(0)
    global_load_dwordx2 v[166:167], v149, s[4:5]
    global_load_ushort v128, v148, s[20:21]
    global_load_ushort v15, v150, s[4:5]
    s_load_dword s50, s[28:29], 0
    s_barrier
    s_and_b32 s14, s31, 15
    s_mov_b32 s15, 0
    s_mov_b32 s33, 0xfff
    s_mov_b32 s54, 0
    s_mov_b32 s55, -1
    v_add_u32 v10, s3, v8
    s_lshl_b32 s42, s3, 7
    v_and_b32 v148, 7, v1
    v_lshlrev_b32 v6, 4, v148
    v_lshl_add_u32 v7, v146, 2, s42
    v_bfe_u32 v160, v1, 2, 3
    v_lshl_add_u32 v161, v144, 4, v160
    v_xor_b32 v148, s3, v160
    v_lshlrev_b32 v148, 5, v148
    v_and_b32 v149, 3, v1
    v_lshl_add_u32 v148, v149, 3, v148
    v_lshl_add_u32 v11, v161, 9, v148
    v_lshl_add_u32 v12, v161, 8, v148
    v_bfe_u32 v148, v1, 2, 1
    v_mul_u32_u24 v151, 640, v148
    v_lshl_add_u32 v148, v2, 4, v151
    v_add_u32 v157, v148, v8
    v_and_b32 v148, 1, v1
    v_mul_u32_u24 v9, 0xaaaa, v148
    v_add_u32 v9, 0x4444, v9
    v_lshl_add_u32 v158, v148, 4, v8
    v_lshl_add_u32 v158, v2, 5, v158
    v_add_u32 v13, v158, v151
    v_lshrrev_b32 v149, 1, v146
    v_xor_b32 v149, v149, v146
    v_and_b32 v149, 4, v149
    v_mul_u32_u24 v149, 3, v149
    v_xor_b32 v148, v146, v149
    v_mul_u32_u24 v149, 640, v144
    v_lshl_add_u32 v148, v148, 1, v149
    v_add_u32 v162, v148, v8
    v_and_b32 v148, 3, v1
    v_lshl_add_u32 v148, v148, 2, v2
    s_lshl_b32 s42, s3, 4
    v_add_u32 v148, s42, v148
    v_lshrrev_b32 v149, 2, v148
    v_xor_b32 v149, v149, v148
    v_and_b32 v149, 2, v149
    v_mul_u32_u24 v149, 5, v149
    v_xor_b32 v148, v148, v149
    v_lshl_add_u32 v148, v148, 1, v151
    v_add_u32 v0, v148, v8
    v_and_b32 v148, 1, v2
    v_lshlrev_b32 v154, 7, v144
    v_lshl_add_u32 v154, v148, 3, v154
    v_add3_u32 v154, v154, v8, s42
    v_lshlrev_b32 v155, 7, v148
    v_lshl_add_u32 v155, v3, 3, v155
    v_add_u32 v155, v155, v8
    v_add_u32 v156, 131072, v11
    s_lshl_b32 s42, s30, 15
    s_lshl_b32 s45, s31, 10
    s_add_u32 s42, s42, s45
    s_add_u32 s42, s42, 4096
    s_and_b32 s45, s42, 0xfffff000
    s_mul_i32 s45, s45, 1
    s_add_u32 s42, s42, s45
    s_add_u32 s42, s42, 4198400
    s_add_u32 s38, s28, s42
    s_addc_u32 s39, s29, 0
    s_mov_b32 s42, 0x3f803f80
    s_cmp_eq_u32 s31, 0
    s_cselect_b32 s44, 1.0, 0
    s_waitcnt vmcnt(0)
    v_dot2_f32_bf16 v112, v166, s42, 0
    v_dot2_f32_bf16 v113, v166, v166, 0
    v_dot2_f32_bf16 v112, v167, s42, v112
    v_dot2_f32_bf16 v113, v167, v167, v113
    v_lshlrev_b32 v128, 16, v128
    v_mul_f32 v130, 0xbfb8aa3b, v128
    v_exp_f32 v130, v130
    v_add_f32_dpp v112, v112, v112 quad_perm:[1,0,3,2] row_mask:0xf bank_mask:0xf
    v_add_f32_dpp v113, v113, v113 quad_perm:[1,0,3,2] row_mask:0xf bank_mask:0xf
    s_nop 0
    v_add_f32_dpp v112, v112, v112 quad_perm:[2,3,0,1] row_mask:0xf bank_mask:0xf
    v_add_f32_dpp v113, v113, v113 quad_perm:[2,3,0,1] row_mask:0xf bank_mask:0xf
    v_add_f32 v130, 1.0, v130
    v_rcp_f32 v130, v130
    v_add_f32_dpp v112, v112, v112 row_half_mirror row_mask:0xf bank_mask:0xf
    v_add_f32_dpp v113, v113, v113 row_half_mirror row_mask:0xf bank_mask:0xf
    v_mul_f32 v128, v128, v130
    v_cvt_pk_bf16_f32 v128, v128, v128
    v_add_f32_dpp v112, v112, v112 row_mirror row_mask:0xf bank_mask:0xf
    v_add_f32_dpp v113, v113, v113 row_mirror row_mask:0xf bank_mask:0xf
    ds_write_b16 v162, v128 offset:3328
    ds_write_b64 v154, v[112:113] offset:128
    v_mov_b32 v146, 1
    ds_write_b8 v10, v146 offset:16
    v_lshlrev_b32 v15, 16, v15
    s_waitcnt lgkmcnt(0)
    v_and_b32 v148, 0xfffff000, v7
    v_mul_u32_u24 v148, 1, v148
    v_add_u32 v10, v7, v148
    s_add_u32 s32, s50, 0x9e5
    s_and_b32 s32, s32, s33
    s_max_u32 s32, s32, 1
    v_mov_b32 v4, s32
    s_mul_i32 s35, s32, 0x00100101
    s_xor_b32 s35, s35, 0x5a5a0000
    v_mov_b32 v5, s35
Sp_15:
    ds_read_b64 v[146:147], v8 offset:16
    s_waitcnt lgkmcnt(0)
    v_cmp_ne_u64 vcc, s[36:37], v[146:147]
    s_cbranch_vccnz Sp_15_r
So_16:
    ds_read_b64 v[112:113], v155 offset:128
    ds_read_b128 v[16:19], v157 offset:3328
    s_waitcnt lgkmcnt(0)
    v_add_f32_dpp v112, v112, v112 quad_perm:[1,0,3,2] row_mask:0xf bank_mask:0xf
    v_add_f32_dpp v113, v113, v113 quad_perm:[1,0,3,2] row_mask:0xf bank_mask:0xf
    s_nop 0
    v_add_f32_dpp v112, v112, v112 quad_perm:[2,3,0,1] row_mask:0xf bank_mask:0xf
    v_add_f32_dpp v113, v113, v113 quad_perm:[2,3,0,1] row_mask:0xf bank_mask:0xf
    s_nop 0
    v_add_f32_dpp v112, v112, v112 row_half_mirror row_mask:0xf bank_mask:0xf
    v_add_f32_dpp v113, v113, v113 row_half_mirror row_mask:0xf bank_mask:0xf
    s_nop 0
    v_add_f32_dpp v112, v112, v112 row_mirror row_mask:0xf bank_mask:0xf
    v_add_f32_dpp v113, v113, v113 row_mirror row_mask:0xf bank_mask:0xf
    v_mul_f32 v112, 0x3a800000, v112
    v_mul_f32 v113, 0x3a800000, v113
    v_fma_f32 v113, -v112, v112, v113
    v_max_f32 v113, 0, v113
    v_add_f32 v113, 0x3727c5ac, v113
    v_rsq_f32 v113, v113
    v_sub_f32 v15, v15, v112
    v_mul_f32 v15, v15, v113
Sp_17:
    ds_read_b128 v[148:151], v8 offset:0
    s_waitcnt lgkmcnt(0)
    v_min_u32 v148, v148, v149
    v_min3_u32 v148, v148, v150, v151
    v_cmp_gt_u32 vcc, 1, v148
    s_cbranch_vccnz Sp_17_r
So_18:
    ds_read_b64_tr_b16 v[48:49], v156 offset:0
    ds_read_b64_tr_b16 v[50:51], v156 offset:4096
    ds_read_b64_tr_b16 v[52:53], v156 offset:256
    ds_read_b64_tr_b16 v[54:55], v156 offset:4352
    s_waitcnt lgkmcnt(0)
    v_mfma_f32_16x16x32_bf16 v[140:143], v[16:19], v[52:55], 0
    v_mfma_f32_16x16x32_bf16 v[136:139], v[16:19], v[48:51], 0
    s_nop 6
    v_add_f32 v140, s44, v140
    v_fmac_f32 v136, v15, v140
    v_add_u32 v136, 0x800, v136
    v_bfi_b32 v136, s33, v4, v136
    s_mov_b32 exec_hi, 0
    global_store_dword v10, v136, s[38:39]
    s_mov_b64 exec, -1
    s_cmp_ge_u32 s2, 128
    s_cbranch_scc1 L_B
    s_and_b32 s94, s30, 3
    s_lshr_b32 s96, s30, 2
    s_and_b32 s95, s14, 7
    s_lshr_b32 s42, s14, 3
    s_lshl_b32 s42, s42, 1
    s_add_u32 s96, s96, s42
    s_lshl_b32 s97, s96, 8
    s_add_u32 s97, s97, 128
    s_add_u32 s96, s96, 4
    v_and_b32 v149, 4, v1
    v_lshlrev_b32 v149, 9, v149
    v_and_b32 v150, 3, v1
    v_lshl_add_u32 v149, v150, 3, v149
    v_lshl_add_u32 v163, v2, 1, v149
    s_lshl_b32 s42, s97, 1
    s_lshl_b32 s45, s3, 5
    s_add_u32 s42, s42, s45
    v_add_u32 v150, s42, v163
    v_min_u32 v151, 4094, v150
    global_load_ushort v164, v151, s[20:21]
    s_cmp_ge_u32 s14, 14
    s_cselect_b32 s46, s30, s3
    s_cselect_b32 s47, s3, s30
    s_lshl_b32 s42, s46, 8
    s_lshl_b32 s45, s47, 5
    s_add_u32 s42, s42, s45
    v_add_u32 v163, s42, v163
    global_load_ushort v14, v163, s[4:5]
    s_lshl_b32 s42, s30, 15
    s_lshl_b32 s45, s3, 12
    s_add_u32 s42, s42, s45
    s_add_u32 s42, s42, 266240
    s_and_b32 s45, s42, 0xfffff000
    s_mul_i32 s45, s45, 1
    s_add_u32 s42, s42, s45
    s_add_u32 s42, s42, 4198400
    s_add_u32 s38, s28, s42
    s_addc_u32 s39, s29, 0
    v_lshlrev_b32 v152, 4, v1
    v_and_b32 v148, 0xfffff000, v152
    v_mul_u32_u24 v148, 1, v148
    v_add_u32 v152, v152, v148
    v_and_b32 v153, 31, v1
    v_lshlrev_b32 v153, 3, v153
    v_lshrrev_b32 v148, 5, v1
    v_lshl_add_u32 v153, v148, 2, v153
    s_mul_i32 s42, s3, 288
    v_add3_u32 v153, v153, v8, s42
    v_lshlrev_b32 v156, 5, v148
    v_bfe_u32 v149, v1, 3, 2
    v_lshl_add_u32 v156, v149, 2, v156
    v_and_b32 v148, 7, v1
    v_mul_u32_u24 v149, 544, v148
    s_lshl_b32 s42, s3, 6
    s_add_u32 s42, s42, 159488
    v_add3_u32 v156, v156, v149, s42
    v_bfe_u32 v149, v1, 1, 3
    v_mul_u32_u24 v157, 544, v149
    v_add_u32 v157, v157, v158
    v_mul_u32_u24 v154, 288, v148
    v_lshl_add_u32 v154, v2, 4, v154
    v_add_u32 v154, v154, v8
    v_lshl_add_u32 v162, v148, 5, v8
    s_lshl_b32 s42, s3, 2
    v_add_u32 v155, s42, v162
    v_mul_u32_u24 v160, 272, v148
    v_lshrrev_b32 v150, 3, v1
    v_lshl_add_u32 v160, v150, 2, v160
    s_lshl_b32 s42, s3, 5
    v_add3_u32 v160, v160, v8, s42
    v_mul_u32_u24 v161, 272, v150
    v_lshl_add_u32 v161, v148, 5, v161
    v_add_u32 v161, v161, v8
    v_lshl_add_u32 v167, v1, 2, v8
    v_xor_b32 v128, v148, v2
    v_lshlrev_b32 v128, 4, v128
    v_lshl_add_u32 v128, v148, 8, v128
    v_and_b32 v148, 8, v1
    v_lshl_add_u32 v128, v148, 9, v128
    s_lshl_b32 s42, s3, 13
    v_add_u32 v128, s42, v128
    v_xor_b32 v129, 64, v128
    v_xor_b32 v130, 128, v128
    v_xor_b32 v131, 192, v128
    s_mov_b32 s52, 0xff00ff00
    s_mov_b32 s53, 0xff00ff00
    v_lshlrev_b32 v166, 15, v2
    v_lshl_add_u32 v166, v3, 3, v166
    v_and_b32 v148, 0xfffff000, v166
    v_mul_u32_u24 v148, 1, v148
    v_add_u32 v166, v166, v148
    v_and_b32 v15, 1, v1
    v_mul_u32_u24 v15, 12, v15
    v_sub_u32 v15, 20, v15
    s_lshl_b32 s42, s3, 1
    s_and_b32 s42, s42, 7
    s_xor_b32 s42, s42, s3
    s_lshl_b32 s42, s42, 5
    s_xor_b32 s42, s42, 32
    v_xor_b32 v159, s42, v12
    v_add_u32 v159, 65536, v159
    s_and_b32 s43, s30, 3
    s_lshr_b32 s44, s30, 2
    s_lshl_b32 s42, s43, 17
    s_lshl_b32 s45, s3, 12
    s_add_u32 s42, s42, s45
    s_lshl_b32 s45, s14, 8
    s_add_u32 s42, s42, s45
    s_lshl_b32 s45, s44, 7
    s_add_u32 s42, s42, s45
    s_add_u32 s42, s42, 528384
    s_and_b32 s45, s42, 0xfffff000
    s_mul_i32 s45, s45, 1
    s_add_u32 s42, s42, s45
    s_add_u32 s42, s42, 4198400
    s_add_u32 s40, s28, s42
    s_addc_u32 s41, s29, 0
    s_add_u32 s56, s40, 32768
    s_addc_u32 s57, s41, 0
    s_mov_b32 s43, 0x3e0293ee
    s_waitcnt vmcnt(0)
    v_lshlrev_b32 v164, 16, v164
    v_mul_f32 v165, 0xbfb8aa3b, v164
    v_exp_f32 v165, v165
    s_nop 0
    v_add_f32 v165, 1.0, v165
    v_rcp_f32 v165, v165
    s_nop 0
    v_mul_f32 v164, v164, v165
    v_cvt_pk_bf16_f32 v164, v164, v164
    ds_write_b16 v0, v164 offset:4608
    v_lshlrev_b32 v14, 16, v14
    v_xor_b32 v145, 32, v159
Sp_19:
    ds_read_b128 v[148:151], v8 offset:0
    s_waitcnt lgkmcnt(0)
    v_min_u32 v148, v148, v149
    v_min3_u32 v148, v148, v150, v151
    v_cmp_gt_u32 vcc, 2, v148
    s_cbranch_vccnz Sp_19_r
So_20:
    ds_read_b128 v[48:51], v128 offset:0
    ds_read_b128 v[64:67], v130 offset:2048
    ds_read_b128 v[52:55], v129 offset:0
    ds_read_b128 v[68:71], v131 offset:2048
    ds_read_b128 v[56:59], v130 offset:0
    ds_read_b128 v[72:75], v128 offset:2048
    ds_read_b128 v[60:63], v131 offset:0
    ds_read_b128 v[76:79], v129 offset:2048
    s_barrier
    global_load_dwordx4 v[112:115], v152, s[38:39] offset:0 sc1
    global_load_dwordx4 v[116:119], v152, s[38:39] offset:1024 sc1
    global_load_dwordx4 v[120:123], v152, s[38:39] offset:2048 sc1
    global_load_dwordx4 v[124:127], v152, s[38:39] offset:3072 sc1
    s_waitcnt lgkmcnt(0)
    s_barrier
    s_cmp_ge_u32 s3, 4
    s_cbranch_scc1 Nv_21
    ds_read_b64_tr_b16 v[80:81], v145 offset:0
    ds_read_b64_tr_b16 v[82:83], v145 offset:2048
    ds_read_b64_tr_b16 v[84:85], v145 offset:8192
    ds_read_b64_tr_b16 v[86:87], v145 offset:10240
    ds_read_b64_tr_b16 v[88:89], v145 offset:16384
    ds_read_b64_tr_b16 v[90:91], v145 offset:18432
    ds_read_b64_tr_b16 v[92:93], v145 offset:24576
    ds_read_b64_tr_b16 v[94:95], v145 offset:26624
    ds_read_b64_tr_b16 v[96:97], v145 offset:32768
    ds_read_b64_tr_b16 v[98:99], v145 offset:34816
    ds_read_b64_tr_b16 v[100:101], v145 offset:40960
    ds_read_b64_tr_b16 v[102:103], v145 offset:43008
    ds_read_b64_tr_b16 v[104:105], v145 offset:49152
    ds_read_b64_tr_b16 v[106:107], v145 offset:51200
    ds_read_b64_tr_b16 v[108:109], v145 offset:57344
    ds_read_b64_tr_b16 v[110:111], v145 offset:59392
    ds_read_b64_tr_b16 v[16:17], v159 offset:0
    ds_read_b64_tr_b16 v[18:19], v159 offset:2048
    ds_read_b64_tr_b16 v[20:21], v159 offset:8192
    ds_read_b64_tr_b16 v[22:23], v159 offset:10240
    ds_read_b64_tr_b16 v[24:25], v159 offset:16384
    ds_read_b64_tr_b16 v[26:27], v159 offset:18432
    ds_read_b64_tr_b16 v[28:29], v159 offset:24576
    ds_read_b64_tr_b16 v[30:31], v159 offset:26624
    ds_read_b64_tr_b16 v[32:33], v159 offset:32768
    ds_read_b64_tr_b16 v[34:35], v159 offset:34816
    ds_read_b64_tr_b16 v[36:37], v159 offset:40960
    ds_read_b64_tr_b16 v[38:39], v159 offset:43008
    ds_read_b64_tr_b16 v[40:41], v159 offset:49152
    ds_read_b64_tr_b16 v[42:43], v159 offset:51200
    ds_read_b64_tr_b16 v[44:45], v159 offset:57344
    ds_read_b64_tr_b16 v[46:47], v159 offset:59392
Nv_21:
    s_waitcnt vmcnt(3)
    v_xor_b32 v112, v112, v4
    v_xor_b32 v113, v113, v4
    v_xor_b32 v114, v114, v4
    v_xor_b32 v115, v115, v4
    v_or_b32 v144, v112, v113
    v_or3_b32 v144, v114, v115, v144
    s_waitcnt vmcnt(2)
    v_xor_b32 v116, v116, v4
    v_xor_b32 v117, v117, v4
    v_xor_b32 v118, v118, v4
    v_xor_b32 v119, v119, v4
    v_or3_b32 v144, v116, v117, v144
    v_or3_b32 v144, v118, v119, v144
    s_waitcnt vmcnt(1)
    v_xor_b32 v120, v120, v4
    v_xor_b32 v121, v121, v4
    v_xor_b32 v122, v122, v4
    v_xor_b32 v123, v123, v4
    v_or3_b32 v144, v120, v121, v144
    v_or3_b32 v144, v122, v123, v144
    s_waitcnt vmcnt(0)
    v_xor_b32 v124, v124, v4
    v_xor_b32 v125, v125, v4
    v_xor_b32 v126, v126, v4
    v_xor_b32 v127, v127, v4
    v_or3_b32 v144, v124, v125, v144
    v_or3_b32 v144, v126, v127, v144
    v_and_b32 v144, s33, v144
    v_cmp_ne_u32 vcc, 0, v144
    s_cbranch_vccnz Rp_23_e
Ok_22:
    v_pk_add_f32 v[112:113], v[112:113], v[116:117]
    v_pk_add_f32 v[114:115], v[114:115], v[118:119]
    v_pk_add_f32 v[120:121], v[120:121], v[124:125]
    v_pk_add_f32 v[122:123], v[122:123], v[126:127]
    v_pk_add_f32 v[112:113], v[112:113], v[120:121]
    v_pk_add_f32 v[114:115], v[114:115], v[122:123]
    s_nop 1
    v_permlane32_swap_b32 v112, v114
    v_permlane32_swap_b32 v113, v115
    v_add_f32 v112, v112, v114
    v_add_f32 v113, v113, v115
    v_cvt_pk_bf16_f32 v112, v112, v113
    ds_write_b32 v153, v112 offset:9728
    s_waitcnt lgkmcnt(0)
    s_barrier
    ds_read_b128 v[112:115], v154 offset:9728
    ds_read_b128 v[116:119], v154 offset:9792
    ds_read_b128 v[120:123], v154 offset:9856
    ds_read_b128 v[124:127], v154 offset:9920
    s_waitcnt lgkmcnt(3)
    v_mfma_f32_16x16x32_bf16 v[136:139], v[48:51], v[112:115], 0
    v_mfma_f32_16x16x32_bf16 v[140:143], v[64:67], v[112:115], 0
    s_waitcnt lgkmcnt(2)
    v_mfma_f32_16x16x32_bf16 v[136:139], v[52:55], v[116:119], v[136:139]
    v_mfma_f32_16x16x32_bf16 v[140:143], v[68:71], v[116:119], v[140:143]
    s_waitcnt lgkmcnt(1)
    v_mfma_f32_16x16x32_bf16 v[136:139], v[56:59], v[120:123], v[136:139]
    v_mfma_f32_16x16x32_bf16 v[140:143], v[72:75], v[120:123], v[140:143]
    s_waitcnt lgkmcnt(0)
    v_mfma_f32_16x16x32_bf16 v[136:139], v[60:63], v[124:127], v[136:139]
    v_mfma_f32_16x16x32_bf16 v[140:143], v[76:79], v[124:127], v[140:143]
    s_nop 7
    v_cndmask_b32 v112, v136, v140, s[52:53]
    v_cndmask_b32 v113, v137, v141, s[52:53]
    v_cndmask_b32 v114, v138, v142, s[52:53]
    v_cndmask_b32 v115, v139, v143, s[52:53]
    v_max_f32 v128, v112, v113
    v_max3_f32 v128, v128, v114, v115
    v_mov_b64 v[136:137], 0
    v_mov_b64 v[138:139], 0
    v_max_f32_dpp v128, v128, v128 row_ror:8 row_mask:0xf bank_mask:0xf
    v_mov_b32 v129, v128
    v_mov_b64 v[140:141], 0
    v_mov_b64 v[142:143], 0
    v_permlane16_swap_b32 v128, v129
    v_max_f32 v128, v128, v129
    v_mov_b32 v129, v128
    s_nop 1
    v_permlane32_swap_b32 v128, v129
    v_max_f32 v128, v128, v129
    s_mov_b64 exec, 0xff
    ds_write_b32 v155, v128 offset:896
    s_mov_b64 exec, -1
    s_waitcnt lgkmcnt(0)
    s_barrier
    ds_read_b128 v[128:131], v162 offset:896
    ds_read_b128 v[132:135], v162 offset:912
    s_waitcnt lgkmcnt(0)
    v_max3_f32 v128, v128, v129, v130
    v_max3_f32 v132, v132, v133, v134
    v_max3_f32 v128, v128, v131, v135
    v_max_f32 v128, v128, v132
    v_mul_f32 v128, s43, v128
    v_fma_f32 v112, v112, s43, -v128
    v_fma_f32 v113, v113, s43, -v128
    v_fma_f32 v114, v114, s43, -v128
    v_fma_f32 v115, v115, s43, -v128
    v_exp_f32 v112, v112
    v_exp_f32 v113, v113
    v_exp_f32 v114, v114
    v_exp_f32 v115, v115
    v_cvt_pk_bf16_f32 v130, v112, v113
    v_cvt_pk_bf16_f32 v131, v114, v115
    ds_write2_b32 v156, v130, v131 offset0:0 offset1:4
    v_add_f32 v112, v112, v113
    v_add_f32 v114, v114, v115
    v_add_f32 v112, v112, v114
    ds_write_b32 v160, v112 offset:1152
    s_waitcnt lgkmcnt(0)
    s_barrier
    s_cmp_ge_u32 s3, 4
    s_cbranch_scc1 L_nopv
    ds_read_b128 v[120:123], v161 offset:1152
    ds_read_b128 v[124:127], v161 offset:1168
    ds_read_b32 v129, v167 offset:896
    ds_read_b128 v[48:51], v157 offset:12032
    ds_read_b128 v[52:55], v157 offset:12160
    ds_read_b128 v[56:59], v157 offset:12288
    ds_read_b128 v[60:63], v157 offset:12416
    s_waitcnt lgkmcnt(3)
    v_smfmac_f32_16x16x64_bf16 v[136:139], v[48:51], v[80:87], v9
    v_smfmac_f32_16x16x64_bf16 v[140:143], v[48:51], v[16:23], v9
    v_pk_add_f32 v[120:121], v[120:121], v[124:125]
    v_pk_add_f32 v[122:123], v[122:123], v[126:127]
    v_add_f32 v120, v120, v121
    v_add_f32 v122, v122, v123
    v_add_f32 v128, v120, v122
    s_waitcnt lgkmcnt(2)
    v_smfmac_f32_16x16x64_bf16 v[136:139], v[52:55], v[88:95], v9
    v_smfmac_f32_16x16x64_bf16 v[140:143], v[52:55], v[24:31], v9
    v_max_f32_dpp v129, v129, v129 quad_perm:[1,0,3,2] row_mask:0xf bank_mask:0xf
    v_add_f32_dpp v128, v128, v128 quad_perm:[1,0,3,2] row_mask:0xf bank_mask:0xf
    s_waitcnt lgkmcnt(1)
    v_smfmac_f32_16x16x64_bf16 v[136:139], v[56:59], v[96:103], v9
    v_smfmac_f32_16x16x64_bf16 v[140:143], v[56:59], v[32:39], v9
    v_max_f32_dpp v129, v129, v129 quad_perm:[2,3,0,1] row_mask:0xf bank_mask:0xf
    v_add_f32_dpp v128, v128, v128 quad_perm:[2,3,0,1] row_mask:0xf bank_mask:0xf
    s_waitcnt lgkmcnt(0)
    v_smfmac_f32_16x16x64_bf16 v[136:139], v[60:63], v[104:111], v9
    v_smfmac_f32_16x16x64_bf16 v[140:143], v[60:63], v[40:47], v9
    v_max_f32_dpp v129, v129, v129 row_half_mirror row_mask:0xf bank_mask:0xf
    v_add_f32_dpp v128, v128, v128 row_half_mirror row_mask:0xf bank_mask:0xf
    v_log_f32 v130, v128
    v_rcp_f32 v128, v128
    v_fmac_f32 v130, s43, v129
    v_mov_b32 v129, v128
    v_lshrrev_b32 v130, v15, v130
    v_add_f32 v112, v136, v137
    v_add_f32 v113, v140, v141
    v_add_f32 v114, v138, v139
    v_add_f32 v115, v142, v143
    v_mov_b32_dpp v129, v128 row_ror:8 row_mask:0xf bank_mask:0x3
    v_mov_b32 v131, v130
    v_mov_b32_dpp v128, v128 row_ror:8 row_mask:0xf bank_mask:0xc
    s_nop 0
    v_mov_b32_dpp v131, v130 row_ror:8 row_mask:0xf bank_mask:0x3
    v_mov_b32_dpp v130, v130 row_ror:8 row_mask:0xf bank_mask:0xc
    v_mul_f32 v112, v112, v128
    v_mul_f32 v113, v113, v128
    v_bfi_b32 v112, s33, v4, v112
    v_bfi_b32 v113, s33, v130, v113
    global_store_dwordx2 v166, v[112:113], s[40:41] sc1
    v_mul_f32 v114, v114, v129
    v_mul_f32 v115, v115, v129
    v_bfi_b32 v114, s33, v4, v114
    v_bfi_b32 v115, s33, v131, v115
    global_store_dwordx2 v166, v[114:115], s[56:57] sc1
L_nopv:
    s_barrier
    ds_read_b128 v[16:19], v13 offset:4608
    ds_read_b128 v[20:23], v13 offset:4736
    v_mov_b64 v[136:137], 0
    v_mov_b64 v[138:139], 0
    v_add_u32 v145, 0, v12
    s_lshl_b32 s42, s95, 15
    s_lshl_b32 s45, s94, 13
    s_add_u32 s42, s42, s45
    s_lshl_b32 s45, s96, 10
    s_add_u32 s42, s42, s45
    s_add_u32 s42, s42, 1183744
    s_and_b32 s45, s42, 0xfffff000
    s_mul_i32 s45, s45, 1
    s_add_u32 s42, s42, s45
    s_add_u32 s42, s42, 4198400
    s_add_u32 s100, s28, s42
    s_addc_u32 s101, s29, 0
Sp_24:
    ds_read_b128 v[148:151], v8 offset:0
    s_waitcnt lgkmcnt(0)
    v_min_u32 v148, v148, v149
    v_min3_u32 v148, v148, v150, v151
    v_cmp_gt_u32 vcc, 3, v148
    s_cbranch_vccnz Sp_24_r
So_25:
    ds_read_b64_tr_b16 v[48:49], v145 offset:0
    ds_read_b64_tr_b16 v[50:51], v145 offset:2048
    ds_read_b64_tr_b16 v[52:53], v145 offset:8192
    ds_read_b64_tr_b16 v[54:55], v145 offset:10240
    ds_read_b64_tr_b16 v[56:57], v145 offset:16384
    ds_read_b64_tr_b16 v[58:59], v145 offset:18432
    ds_read_b64_tr_b16 v[60:61], v145 offset:24576
    ds_read_b64_tr_b16 v[62:63], v145 offset:26624
    s_waitcnt lgkmcnt(4)
    v_smfmac_f32_16x16x64_bf16 v[136:139], v[16:19], v[48:55], v9
    s_waitcnt lgkmcnt(0)
    v_smfmac_f32_16x16x64_bf16 v[136:139], v[20:23], v[56:63], v9
    s_nop 7
    v_add_f32 v136, v136, v137
    v_add_u32 v136, 0x800, v136
    v_bfi_b32 v136, s33, v4, v136
    s_mov_b32 exec_hi, 0
    global_store_dword v10, v136, s[100:101] sc1
    s_mov_b64 exec, -1
    v_lshrrev_b32 v160, 3, v1
    v_lshl_add_u32 v152, v160, 10, v6
    v_lshl_add_u32 v153, v160, 11, v6
    v_and_b32 v148, 0xfffff000, v152
    v_mul_u32_u24 v148, 1, v148
    v_add_u32 v152, v152, v148
    v_and_b32 v148, 0xfffff000, v153
    v_mul_u32_u24 v148, 1, v148
    v_add_u32 v153, v153, v148
    s_lshl_b32 s42, s46, 15
    s_lshl_b32 s45, s47, 7
    s_add_u32 s42, s42, s45
    s_add_u32 s42, s42, 1183744
    s_and_b32 s45, s42, 0xfffff000
    s_mul_i32 s45, s45, 1
    s_add_u32 s42, s42, s45
    s_add_u32 s42, s42, 4198400
    s_add_u32 s38, s28, s42
    s_addc_u32 s39, s29, 0
    s_add_u32 s40, s38, 16384
    s_addc_u32 s41, s39, 0
    s_add_u32 s56, s38, 32768
    s_addc_u32 s57, s39, 0
    s_lshl_b32 s42, s46, 14
    s_lshl_b32 s45, s47, 7
    s_add_u32 s42, s42, s45
    s_add_u32 s42, s42, 1052672
    s_and_b32 s45, s42, 0xfffff000
    s_mul_i32 s45, s45, 1
    s_add_u32 s42, s42, s45
    s_add_u32 s42, s42, 4198400
    s_add_u32 s98, s28, s42
    s_addc_u32 s99, s29, 0
    s_cmp_ge_u32 s14, 14
    s_cbranch_scc1 L_final
    v_add_u32 v157, 65536, v11
    v_lshrrev_b32 v154, 5, v1
    v_lshl_add_u32 v154, v154, 13, v7
    v_lshlrev_b32 v154, 1, v154
    v_bfe_u32 v155, v1, 3, 1
    v_lshlrev_b32 v155, 1, v155
    v_and_b32 v148, 2, v1
    v_cmp_ne_u32 vcc, 0, v148
    s_nop 1
    v_cndmask_b32 v155, v155, 1, vcc
    v_mul_u32_u24 v155, 1280, v155
    v_add_u32 v155, v155, v13
    v_and_b32 v156, 4, v1
    v_lshlrev_b32 v156, 6, v156
    v_lshl_add_u32 v156, v2, 3, v156
    s_lshl_b32 s42, s3, 5
    v_add3_u32 v156, v156, v8, s42
    v_mov_b64 v[136:137], 0
    v_mov_b64 v[138:139], 0
    v_mov_b64 v[140:141], 0
    v_mov_b64 v[142:143], 0
    s_barrier
    global_load_dwordx4 v[80:83], v152, s[38:39] offset:0 sc1
    global_load_dwordx4 v[84:87], v152, s[40:41] offset:0 sc1
    global_load_dwordx4 v[88:91], v152, s[56:57] offset:0 sc1
    s_barrier
    ds_read_b64_tr_b16 v[48:49], v157 offset:0
    ds_read_b64_tr_b16 v[50:51], v157 offset:4096
    ds_read_b64_tr_b16 v[52:53], v157 offset:16384
    ds_read_b64_tr_b16 v[54:55], v157 offset:20480
    ds_read_b64_tr_b16 v[64:65], v157 offset:256
    ds_read_b64_tr_b16 v[66:67], v157 offset:4352
    ds_read_b64_tr_b16 v[68:69], v157 offset:16640
    ds_read_b64_tr_b16 v[70:71], v157 offset:20736
    ds_read_b64_tr_b16 v[56:57], v157 offset:32768
    ds_read_b64_tr_b16 v[58:59], v157 offset:36864
    ds_read_b64_tr_b16 v[60:61], v157 offset:49152
    ds_read_b64_tr_b16 v[62:63], v157 offset:53248
    ds_read_b64_tr_b16 v[72:73], v157 offset:33024
    ds_read_b64_tr_b16 v[74:75], v157 offset:37120
    ds_read_b64_tr_b16 v[76:77], v157 offset:49408
    ds_read_b64_tr_b16 v[78:79], v157 offset:53504
    s_waitcnt vmcnt(2)
    v_xor_b32 v80, v80, v4
    v_xor_b32 v81, v81, v4
    v_xor_b32 v82, v82, v4
    v_xor_b32 v83, v83, v4
    v_or_b32 v144, v80, v81
    v_or3_b32 v144, v82, v83, v144
    s_waitcnt vmcnt(1)
    v_xor_b32 v84, v84, v4
    v_xor_b32 v85, v85, v4
    v_xor_b32 v86, v86, v4
    v_xor_b32 v87, v87, v4
    v_or3_b32 v144, v84, v85, v144
    v_or3_b32 v144, v86, v87, v144
    s_waitcnt vmcnt(0)
    v_xor_b32 v88, v88, v4
    v_xor_b32 v89, v89, v4
    v_xor_b32 v90, v90, v4
    v_xor_b32 v91, v91, v4
    v_or3_b32 v144, v88, v89, v144
    v_or3_b32 v144, v90, v91, v144
    v_and_b32 v144, s33, v144
    v_cmp_ne_u32 vcc, 0, v144
    s_cbranch_vccnz Rp_27_e
    global_load_dwordx4 v[112:115], v153, s[98:99] offset:0 sc1
    global_load_dwordx4 v[116:119], v153, s[98:99] offset:1024 sc1
Ok_26:
    v_permlane32_swap_b32 v80, v82
    v_permlane32_swap_b32 v81, v83
    v_permlane32_swap_b32 v84, v86
    v_permlane32_swap_b32 v85, v87
    v_permlane32_swap_b32 v88, v90
    v_permlane32_swap_b32 v89, v91
    v_add_f32 v80, v80, v82
    v_add_f32 v81, v81, v83
    v_add_f32 v84, v84, v86
    v_add_f32 v85, v85, v87
    v_add_f32 v88, v88, v90
    v_add_f32 v89, v89, v91
    v_permlane16_swap_b32 v80, v81
    v_permlane16_swap_b32 v84, v85
    v_permlane16_swap_b32 v88, v89
    v_add_f32 v80, v80, v81
    v_add_f32 v84, v84, v85
    v_add_f32 v88, v88, v89
    v_add_f32_dpp v80, v80, v80 row_ror:8 row_mask:0xf bank_mask:0xf
    v_add_f32_dpp v84, v84, v84 row_ror:8 row_mask:0xf bank_mask:0xf
    v_add_f32_dpp v88, v88, v88 row_ror:8 row_mask:0xf bank_mask:0xf
    v_cvt_pk_bf16_f32 v88, v88, v88
    v_lshlrev_b32 v88, 16, v88
    v_cvt_pk_bf16_f32 v164, v80, v80
    v_lshlrev_b32 v164, 16, v164
    v_add_f32 v165, 1.0, v88
    v_cvt_pk_bf16_f32 v84, v84, v84
    v_cvt_pk_bf16_f32 v82, v165, v165
    v_lshlrev_b32 v165, 16, v82
    ds_write_b16 v0, v82 offset:7168
    ds_write_b16 v0, v84 offset:8448
    s_lshl_b32 s42, s14, 15
    s_lshl_b32 s45, s30, 11
    s_add_u32 s42, s42, s45
    s_add_u32 s42, s42, 1445888
    s_add_u32 s56, s28, s42
    s_addc_u32 s57, s29, 0
    s_waitcnt vmcnt(1)
    v_xor_b32 v112, v112, v4
    v_xor_b32 v113, v113, v4
    v_xor_b32 v114, v114, v4
    v_xor_b32 v115, v115, v4
    v_or_b32 v144, v112, v113
    v_or3_b32 v144, v114, v115, v144
    s_waitcnt vmcnt(0)
    v_xor_b32 v116, v116, v4
    v_xor_b32 v117, v117, v4
    v_xor_b32 v118, v118, v4
    v_xor_b32 v119, v119, v4
    v_or3_b32 v144, v116, v117, v144
    v_or3_b32 v144, v118, v119, v144
    v_and_b32 v144, s33, v144
    v_cmp_ne_u32 vcc, 0, v144
    s_cbranch_vccnz Rp_29_e
Ok_28:
    v_pk_add_f32 v[112:113], v[112:113], v[116:117]
    v_pk_add_f32 v[114:115], v[114:115], v[118:119]
    s_nop 1
    v_permlane32_swap_b32 v112, v114
    v_permlane32_swap_b32 v113, v115
    v_add_f32 v112, v112, v114
    v_add_f32 v113, v113, v115
    s_nop 1
    v_permlane16_swap_b32 v112, v113
    v_add_f32 v112, v112, v113
    s_nop 1
    v_add_f32_dpp v112, v112, v112 row_ror:8 row_mask:0xf bank_mask:0xf
    v_fmac_f32 v14, v164, v112
    v_mul_f32 v112, v14, v165
    v_mul_f32 v115, v14, v14
    v_cvt_pk_bf16_f32 v112, v112, v112
    v_add_f32_dpp v114, v14, v14 quad_perm:[1,0,3,2] row_mask:0xf bank_mask:0xf
    v_add_f32_dpp v115, v115, v115 quad_perm:[1,0,3,2] row_mask:0xf bank_mask:0xf
    ds_write_b16 v0, v112 offset:5888
    v_add_f32_dpp v114, v114, v114 quad_perm:[2,3,0,1] row_mask:0xf bank_mask:0xf
    v_add_f32_dpp v115, v115, v115 quad_perm:[2,3,0,1] row_mask:0xf bank_mask:0xf
    ds_write_b64 v156, v[114:115] offset:384
    s_waitcnt lgkmcnt(0)
    s_barrier
    ds_read_b128 v[16:19], v155 offset:5888
    ds_read_b128 v[20:23], v155 offset:6016
    s_waitcnt lgkmcnt(1)
    v_smfmac_f32_16x16x64_bf16 v[136:139], v[16:19], v[48:55], v9
    v_smfmac_f32_16x16x64_bf16 v[140:143], v[16:19], v[64:71], v9
    s_waitcnt lgkmcnt(0)
    v_smfmac_f32_16x16x64_bf16 v[136:139], v[20:23], v[56:63], v9
    v_smfmac_f32_16x16x64_bf16 v[140:143], v[20:23], v[72:79], v9
    s_nop 6
    v_add_f32 v112, v136, v137
    v_add_f32 v113, v140, v141
    v_add_f32 v114, v138, v139
    v_add_f32 v115, v142, v143
    v_permlane32_swap_b32 v112, v113
    v_cndmask_b32 v114, v114, v115, s[54:55]
    v_add_u32 v112, 0x800, v112
    v_bfi_b32 v112, s33, v4, v112
    v_cvt_pk_bf16_f32 v113, v114, v113
    global_store_dwordx2 v154, v[112:113], s[56:57] sc1
    s_branch L_fin
L_final:
    s_lshr_b32 s42, s3, 2
    s_add_u32 s42, s42, 14
    s_cmp_lg_u32 s14, s42
    s_cbranch_scc1 L_fin
    s_add_u32 s58, s38, 49152
    s_addc_u32 s59, s39, 0
    v_cmp_gt_u32 s[52:53], 7, v160
    v_min_u32 v160, 6, v160
    v_lshl_add_u32 v160, v160, 11, v6
    s_mul_i32 s42, s30, 14336
    s_lshl_b32 s45, s3, 7
    s_add_u32 s42, s42, s45
    s_add_u32 s42, s42, 2019328
    s_add_u32 s100, s28, s42
    s_addc_u32 s101, s29, 0
    s_mov_b32 s92, 60
    global_load_dwordx4 v[112:115], v160, s[100:101] offset:0 sc1
    global_load_dwordx4 v[116:119], v160, s[100:101] offset:1024 sc1
    s_lshl_b32 s42, s30, 11
    s_lshl_b32 s45, s3, 7
    s_add_u32 s42, s42, s45
    s_add_u32 s42, s42, 2183168
    s_add_u32 s40, s28, s42
    s_addc_u32 s41, s29, 0
    s_mov_b32 s43, 60
    v_mov_b32 v145, 0
L_fh:
    global_load_dword v146, v145, s[40:41] sc1
    s_waitcnt vmcnt(0)
    v_cmp_ne_u32 vcc, v146, v5
    s_cbranch_vccz L_fho
    s_sleep 2
    s_sub_u32 s43, s43, 1
    s_cbranch_scc0 L_fh
L_fho:
    global_load_dwordx4 v[80:83], v152, s[38:39] offset:0 sc1
    global_load_dwordx4 v[84:87], v152, s[58:59] offset:0 sc1
    global_load_dwordx4 v[112:115], v153, s[98:99] offset:0 sc1
    global_load_dwordx4 v[116:119], v153, s[98:99] offset:1024 sc1
    s_waitcnt vmcnt(3)
    v_xor_b32 v80, v80, v4
    v_xor_b32 v81, v81, v4
    v_xor_b32 v82, v82, v4
    v_xor_b32 v83, v83, v4
    v_or_b32 v144, v80, v81
    v_or3_b32 v144, v82, v83, v144
    s_waitcnt vmcnt(2)
    v_xor_b32 v84, v84, v4
    v_xor_b32 v85, v85, v4
    v_xor_b32 v86, v86, v4
    v_xor_b32 v87, v87, v4
    v_or3_b32 v144, v84, v85, v144
    v_or3_b32 v144, v86, v87, v144
    s_waitcnt vmcnt(1)
    v_xor_b32 v112, v112, v4
    v_xor_b32 v113, v113, v4
    v_xor_b32 v114, v114, v4
    v_xor_b32 v115, v115, v4
    v_or3_b32 v144, v112, v113, v144
    v_or3_b32 v144, v114, v115, v144
    s_waitcnt vmcnt(0)
    v_xor_b32 v116, v116, v4
    v_xor_b32 v117, v117, v4
    v_xor_b32 v118, v118, v4
    v_xor_b32 v119, v119, v4
    v_or3_b32 v144, v116, v117, v144
    v_or3_b32 v144, v118, v119, v144
    v_and_b32 v144, s33, v144
    v_cmp_ne_u32 vcc, 0, v144
    s_cbranch_vccnz Rp_31_e
Ok_30:
    v_pk_add_f32 v[112:113], v[112:113], v[116:117]
    v_pk_add_f32 v[114:115], v[114:115], v[118:119]
    s_nop 1
    v_permlane32_swap_b32 v112, v114
    v_permlane32_swap_b32 v113, v115
    v_permlane32_swap_b32 v80, v82
    v_permlane32_swap_b32 v81, v83
    v_permlane32_swap_b32 v84, v86
    v_permlane32_swap_b32 v85, v87
    v_add_f32 v112, v112, v114
    v_add_f32 v113, v113, v115
    v_add_f32 v80, v80, v82
    v_add_f32 v81, v81, v83
    v_add_f32 v84, v84, v86
    v_add_f32 v85, v85, v87
    v_permlane16_swap_b32 v112, v113
    v_permlane16_swap_b32 v80, v81
    v_permlane16_swap_b32 v84, v85
    v_add_f32 v112, v112, v113
    v_add_f32 v80, v80, v81
    v_add_f32 v84, v84, v85
    v_add_f32_dpp v112, v112, v112 row_ror:8 row_mask:0xf bank_mask:0xf
    v_add_f32_dpp v80, v80, v80 row_ror:8 row_mask:0xf bank_mask:0xf
    v_add_f32_dpp v84, v84, v84 row_ror:8 row_mask:0xf bank_mask:0xf
    v_cvt_pk_bf16_f32 v80, v80, v80
    v_lshlrev_b32 v80, 16, v80
    v_cvt_pk_bf16_f32 v84, v84, v84
    v_lshlrev_b32 v84, 16, v84
    v_fmac_f32 v14, v80, v112
    s_add_u32 s42, s30, s3
    s_cmp_lg_u32 s42, 0
    s_cbranch_scc1 L_noep
    s_mov_b64 exec, 1
    global_store_dword v145, v4, s[28:29]
    s_mov_b64 exec, -1
L_noep:
    s_mov_b32 s92, 40
    global_load_dwordx4 v[112:115], v160, s[100:101] offset:0 sc1
    global_load_dwordx4 v[116:119], v160, s[100:101] offset:1024 sc1
L_f6:
    global_load_dwordx4 v[120:123], v160, s[100:101] offset:0 sc1
    global_load_dwordx4 v[124:127], v160, s[100:101] offset:1024 sc1
    s_waitcnt vmcnt(2)
    v_xor_b32 v112, v112, v4
    v_xor_b32 v113, v113, v4
    v_xor_b32 v114, v114, v4
    v_xor_b32 v115, v115, v4
    v_xor_b32 v116, v116, v4
    v_xor_b32 v117, v117, v4
    v_xor_b32 v118, v118, v4
    v_xor_b32 v119, v119, v4
    v_or_b32 v144, v112, v113
    v_or3_b32 v144, v114, v115, v144
    v_or3_b32 v144, v116, v117, v144
    v_or3_b32 v144, v118, v119, v144
    v_and_b32 v144, s33, v144
    v_cmp_ne_u32 vcc, 0, v144
    s_cbranch_vccz L_f6a
    global_load_dwordx4 v[112:115], v160, s[100:101] offset:0 sc1
    global_load_dwordx4 v[116:119], v160, s[100:101] offset:1024 sc1
    s_waitcnt vmcnt(2)
    v_xor_b32 v120, v120, v4
    v_xor_b32 v121, v121, v4
    v_xor_b32 v122, v122, v4
    v_xor_b32 v123, v123, v4
    v_xor_b32 v124, v124, v4
    v_xor_b32 v125, v125, v4
    v_xor_b32 v126, v126, v4
    v_xor_b32 v127, v127, v4
    v_or_b32 v144, v120, v121
    v_or3_b32 v144, v122, v123, v144
    v_or3_b32 v144, v124, v125, v144
    v_or3_b32 v144, v126, v127, v144
    v_and_b32 v144, s33, v144
    v_cmp_ne_u32 vcc, 0, v144
    s_cbranch_vccz L_f6b
    s_sub_u32 s92, s92, 1
    s_cbranch_scc0 L_f6
    s_sub_u32 s100, s100, 114688
    s_subb_u32 s101, s101, 0
    s_waitcnt vmcnt(0)
    global_load_dwordx4 v[112:115], v160, s[100:101] offset:0 sc1
    global_load_dwordx4 v[116:119], v160, s[100:101] offset:1024 sc1
    s_waitcnt vmcnt(1)
    v_xor_b32 v112, v112, v4
    v_xor_b32 v113, v113, v4
    v_xor_b32 v114, v114, v4
    v_xor_b32 v115, v115, v4
    v_or_b32 v144, v112, v113
    v_or3_b32 v144, v114, v115, v144
    s_waitcnt vmcnt(0)
    v_xor_b32 v116, v116, v4
    v_xor_b32 v117, v117, v4
    v_xor_b32 v118, v118, v4
    v_xor_b32 v119, v119, v4
    v_or3_b32 v144, v116, v117, v144
    v_or3_b32 v144, v118, v119, v144
    v_and_b32 v144, s33, v144
    v_cmp_ne_u32 vcc, 0, v144
    s_cbranch_vccnz Rp_33_e
Ok_32:
L_f6a:
    v_pk_add_f32 v[128:129], v[112:113], v[116:117]
    v_pk_add_f32 v[130:131], v[114:115], v[118:119]
L_f6c:
    v_cndmask_b32 v128, 0, v128, s[52:53]
    v_cndmask_b32 v129, 0, v129, s[52:53]
    v_cndmask_b32 v130, 0, v130, s[52:53]
    v_cndmask_b32 v131, 0, v131, s[52:53]
    s_nop 0
    v_permlane32_swap_b32 v128, v130
    v_permlane32_swap_b32 v129, v131
    v_add_f32 v128, v128, v130
    v_add_f32 v129, v129, v131
    s_nop 1
    v_permlane16_swap_b32 v128, v129
    v_add_f32 v128, v128, v129
    s_nop 1
    v_add_f32_dpp v128, v128, v128 row_ror:8 row_mask:0xf bank_mask:0xf
    v_fmac_f32 v14, v84, v128
    v_cvt_pk_bf16_f32 v14, v14, v14
    s_mov_b32 exec_lo, 0x00ff00ff
    s_mov_b32 exec_hi, 0x00ff00ff
    global_store_short v163, v14, s[24:25]
    s_mov_b64 exec, -1
    s_branch L_fin
L_B:
    s_and_b32 s94, s30, 3
    s_lshr_b32 s96, s30, 2
    s_lshr_b32 s95, s14, 1
    s_xor_b32 s95, s95, 1
    s_and_b32 s42, s14, 1
    s_lshl_b32 s42, s42, 1
    s_add_u32 s96, s96, s42
    s_lshl_b32 s97, s96, 8
    v_and_b32 v149, 4, v1
    v_lshlrev_b32 v149, 9, v149
    v_and_b32 v150, 3, v1
    v_lshl_add_u32 v149, v150, 3, v149
    v_lshl_add_u32 v163, v2, 1, v149
    s_lshl_b32 s42, s97, 1
    s_lshl_b32 s45, s3, 5
    s_add_u32 s42, s42, s45
    v_add_u32 v150, s42, v163
    v_min_u32 v151, 4094, v150
    global_load_ushort v164, v151, s[20:21]
    s_lshl_b32 s42, s30, 15
    s_lshl_b32 s45, s3, 7
    s_add_u32 s42, s42, s45
    s_add_u32 s42, s42, 4096
    s_and_b32 s45, s42, 0xfffff000
    s_mul_i32 s45, s45, 1
    s_add_u32 s42, s42, s45
    s_add_u32 s42, s42, 4198400
    s_add_u32 s38, s28, s42
    s_addc_u32 s39, s29, 0
    v_lshrrev_b32 v153, 3, v1
    v_lshl_add_u32 v153, v153, 12, v6
    v_and_b32 v148, 0xfffff000, v153
    v_mul_u32_u24 v148, 1, v148
    v_add_u32 v153, v153, v148
    s_lshl_b32 s42, s3, 1
    s_and_b32 s42, s42, 7
    s_xor_b32 s42, s42, s3
    s_lshl_b32 s42, s42, 5
    s_lshr_b32 s43, s3, 2
    s_lshl_b32 s44, s43, 8
    v_xor_b32 v154, s42, v11
    v_add_u32 v154, s44, v154
    v_xor_b32 v155, 32, v154
    v_bfe_u32 v151, v1, 3, 1
    v_mul_u32_u24 v151, 640, v151
    v_add_u32 v156, v158, v151
    v_lshrrev_b32 v157, 5, v1
    v_and_b32 v149, 511, v7
    v_lshl_add_u32 v157, v157, 17, v149
    v_and_b32 v148, 0xfffff000, v157
    v_mul_u32_u24 v148, 1, v148
    v_add_u32 v157, v157, v148
    s_lshl_b32 s42, s43, 12
    s_lshl_b32 s45, s14, 13
    s_add_u32 s42, s42, s45
    s_lshl_b32 s45, s30, 9
    s_add_u32 s42, s42, s45
    s_add_u32 s42, s42, 266240
    s_and_b32 s45, s42, 0xfffff000
    s_mul_i32 s45, s45, 1
    s_add_u32 s42, s42, s45
    s_add_u32 s42, s42, 4198400
    s_add_u32 s40, s28, s42
    s_addc_u32 s41, s29, 0
    s_mov_b32 s52, 0xffff0000
    s_mov_b32 s53, 0xffff0000
    s_and_b32 s42, s14, 1
    s_lshl_b32 s46, s30, 1
    s_add_u32 s46, s46, s42
    s_lshr_b32 s47, s14, 1
    s_lshl_b32 s42, s46, 12
    s_lshl_b32 s45, s3, 16
    s_add_u32 s42, s42, s45
    s_add_u32 s42, s42, 528384
    s_and_b32 s45, s42, 0xfffff000
    s_mul_i32 s45, s45, 1
    s_add_u32 s42, s42, s45
    s_add_u32 s42, s42, 4198400
    s_add_u32 s56, s28, s42
    s_addc_u32 s57, s29, 0
    s_lshl_b32 s42, s47, 14
    s_lshl_b32 s45, s46, 10
    s_add_u32 s42, s42, s45
    s_add_u32 s42, s42, 1052672
    s_and_b32 s45, s42, 0xfffff000
    s_mul_i32 s45, s45, 1
    s_add_u32 s42, s42, s45
    s_add_u32 s42, s42, 4198400
    s_add_u32 s58, s28, s42
    s_addc_u32 s59, s29, 0
    v_lshlrev_b32 v160, 4, v1
    v_and_b32 v148, 0xfffff000, v160
    v_mul_u32_u24 v148, 1, v148
    v_add_u32 v160, v160, v148
    v_and_b32 v148, 1, v2
    v_lshlrev_b32 v148, 4, v148
    v_and_b32 v149, 7, v1
    v_lshl_add_u32 v148, v149, 1, v148
    v_lshrrev_b32 v149, 5, v1
    v_add_u32 v148, v148, v149
    v_lshrrev_b32 v149, 2, v148
    v_xor_b32 v149, v149, v148
    v_and_b32 v149, 2, v149
    v_mul_u32_u24 v149, 5, v149
    v_xor_b32 v148, v148, v149
    v_lshl_add_u32 v148, v148, 1, v151
    s_lshl_b32 s42, s3, 6
    v_add3_u32 v161, v148, v8, s42
    v_mov_b64 v[136:137], 0
    v_mov_b64 v[138:139], 0
    v_mov_b64 v[140:141], 0
    v_mov_b64 v[142:143], 0
    s_barrier
    global_load_dwordx4 v[112:115], v153, s[38:39] offset:0 sc1
    global_load_dwordx4 v[116:119], v153, s[38:39] offset:1024 sc1
    global_load_dwordx4 v[120:123], v153, s[38:39] offset:2048 sc1
    global_load_dwordx4 v[124:127], v153, s[38:39] offset:3072 sc1
    s_waitcnt vmcnt(4)
    v_lshlrev_b32 v164, 16, v164
    v_mul_f32 v165, 0xbfb8aa3b, v164
    v_exp_f32 v165, v165
    s_nop 0
    v_add_f32 v165, 1.0, v165
    v_rcp_f32 v165, v165
    s_nop 0
    v_mul_f32 v164, v164, v165
    v_cvt_pk_bf16_f32 v164, v164, v164
    ds_write_b16 v0, v164 offset:4608
    s_barrier
    ds_read_b64_tr_b16 v[48:49], v154 offset:0
    ds_read_b64_tr_b16 v[50:51], v154 offset:4096
    ds_read_b64_tr_b16 v[52:53], v154 offset:16384
    ds_read_b64_tr_b16 v[54:55], v154 offset:20480
    ds_read_b64_tr_b16 v[64:65], v155 offset:0
    ds_read_b64_tr_b16 v[66:67], v155 offset:4096
    ds_read_b64_tr_b16 v[68:69], v155 offset:16384
    ds_read_b64_tr_b16 v[70:71], v155 offset:20480
    ds_read_b64_tr_b16 v[56:57], v154 offset:32768
    ds_read_b64_tr_b16 v[58:59], v154 offset:36864
    ds_read_b64_tr_b16 v[60:61], v154 offset:49152
    ds_read_b64_tr_b16 v[62:63], v154 offset:53248
    ds_read_b64_tr_b16 v[72:73], v155 offset:32768
    ds_read_b64_tr_b16 v[74:75], v155 offset:36864
    ds_read_b64_tr_b16 v[76:77], v155 offset:49152
    ds_read_b64_tr_b16 v[78:79], v155 offset:53248
    s_waitcnt vmcnt(3)
    v_xor_b32 v112, v112, v4
    v_xor_b32 v113, v113, v4
    v_xor_b32 v114, v114, v4
    v_xor_b32 v115, v115, v4
    v_or_b32 v144, v112, v113
    v_or3_b32 v144, v114, v115, v144
    s_waitcnt vmcnt(2)
    v_xor_b32 v116, v116, v4
    v_xor_b32 v117, v117, v4
    v_xor_b32 v118, v118, v4
    v_xor_b32 v119, v119, v4
    v_or3_b32 v144, v116, v117, v144
    v_or3_b32 v144, v118, v119, v144
    s_waitcnt vmcnt(1)
    v_xor_b32 v120, v120, v4
    v_xor_b32 v121, v121, v4
    v_xor_b32 v122, v122, v4
    v_xor_b32 v123, v123, v4
    v_or3_b32 v144, v120, v121, v144
    v_or3_b32 v144, v122, v123, v144
    s_waitcnt vmcnt(0)
    v_xor_b32 v124, v124, v4
    v_xor_b32 v125, v125, v4
    v_xor_b32 v126, v126, v4
    v_xor_b32 v127, v127, v4
    v_or3_b32 v144, v124, v125, v144
    v_or3_b32 v144, v126, v127, v144
    v_and_b32 v144, s33, v144
    v_cmp_ne_u32 vcc, 0, v144
    s_cbranch_vccnz Rp_35_e
Ok_34:
    v_pk_add_f32 v[112:113], v[112:113], v[116:117]
    v_pk_add_f32 v[114:115], v[114:115], v[118:119]
    v_pk_add_f32 v[120:121], v[120:121], v[124:125]
    v_pk_add_f32 v[122:123], v[122:123], v[126:127]
    v_pk_add_f32 v[112:113], v[112:113], v[120:121]
    v_pk_add_f32 v[114:115], v[114:115], v[122:123]
    s_nop 1
    v_permlane32_swap_b32 v112, v114
    v_permlane32_swap_b32 v113, v115
    v_add_f32 v112, v112, v114
    v_add_f32 v113, v113, v115
    s_nop 1
    v_permlane16_swap_b32 v112, v113
    v_add_f32 v112, v112, v113
    s_nop 1
    v_add_f32_dpp v112, v112, v112 row_ror:8 row_mask:0xf bank_mask:0xf
    v_cvt_pk_bf16_f32 v112, v112, v112
    ds_write_b16 v0, v112 offset:5888
    s_waitcnt lgkmcnt(0)
    s_barrier
    ds_read_b128 v[16:19], v156 offset:5888
    ds_read_b128 v[20:23], v156 offset:6016
    s_waitcnt lgkmcnt(1)
    v_smfmac_f32_16x16x64_bf16 v[136:139], v[16:19], v[48:55], v9
    v_smfmac_f32_16x16x64_bf16 v[140:143], v[16:19], v[64:71], v9
    s_waitcnt lgkmcnt(0)
    v_smfmac_f32_16x16x64_bf16 v[136:139], v[20:23], v[56:63], v9
    v_smfmac_f32_16x16x64_bf16 v[140:143], v[20:23], v[72:79], v9
    s_nop 6
    v_add_f32 v112, v136, v137
    v_add_f32 v113, v140, v141
    v_cndmask_b32 v112, v112, v113, s[52:53]
    v_add_u32 v112, 0x800, v112
    v_bfi_b32 v112, s33, v4, v112
    global_store_dword v157, v112, s[40:41] sc1
    s_barrier
    ds_read_b128 v[16:19], v13 offset:4608
    ds_read_b128 v[20:23], v13 offset:4736
    v_mov_b64 v[136:137], 0
    v_mov_b64 v[138:139], 0
    v_add_u32 v145, 65536, v12
    s_lshl_b32 s42, s95, 15
    s_lshl_b32 s45, s94, 13
    s_add_u32 s42, s42, s45
    s_lshl_b32 s45, s96, 10
    s_add_u32 s42, s42, s45
    s_add_u32 s42, s42, 1183744
    s_and_b32 s45, s42, 0xfffff000
    s_mul_i32 s45, s45, 1
    s_add_u32 s42, s42, s45
    s_add_u32 s42, s42, 4198400
    s_add_u32 s100, s28, s42
    s_addc_u32 s101, s29, 0
Sp_36:
    ds_read_b128 v[148:151], v8 offset:0
    s_waitcnt lgkmcnt(0)
    v_min_u32 v148, v148, v149
    v_min3_u32 v148, v148, v150, v151
    v_cmp_gt_u32 vcc, 3, v148
    s_cbranch_vccnz Sp_36_r
So_37:
    ds_read_b64_tr_b16 v[48:49], v145 offset:0
    ds_read_b64_tr_b16 v[50:51], v145 offset:2048
    ds_read_b64_tr_b16 v[52:53], v145 offset:8192
    ds_read_b64_tr_b16 v[54:55], v145 offset:10240
    ds_read_b64_tr_b16 v[56:57], v145 offset:16384
    ds_read_b64_tr_b16 v[58:59], v145 offset:18432
    ds_read_b64_tr_b16 v[60:61], v145 offset:24576
    ds_read_b64_tr_b16 v[62:63], v145 offset:26624
    s_waitcnt lgkmcnt(4)
    v_smfmac_f32_16x16x64_bf16 v[136:139], v[16:19], v[48:55], v9
    s_waitcnt lgkmcnt(0)
    v_smfmac_f32_16x16x64_bf16 v[136:139], v[20:23], v[56:63], v9
    s_nop 7
    v_add_f32 v136, v136, v137
    v_add_u32 v136, 0x800, v136
    v_bfi_b32 v136, s33, v4, v136
    s_mov_b32 exec_hi, 0
    global_store_dword v10, v136, s[100:101] sc1
    s_mov_b64 exec, -1
    s_mov_b32 s44, 0x000fff00
    v_mov_b64 v[136:137], 0
    v_mov_b64 v[138:139], 0
    s_barrier
    global_load_dwordx4 v[112:115], v160, s[56:57] offset:0 sc1
    global_load_dwordx4 v[116:119], v160, s[56:57] offset:1024 sc1
    global_load_dwordx4 v[120:123], v160, s[56:57] offset:2048 sc1
    global_load_dwordx4 v[124:127], v160, s[56:57] offset:3072 sc1
    s_barrier
    ds_read_b64_tr_b16 v[48:49], v12 offset:0
    ds_read_b64_tr_b16 v[50:51], v12 offset:2048
    ds_read_b64_tr_b16 v[52:53], v12 offset:8192
    ds_read_b64_tr_b16 v[54:55], v12 offset:10240
    ds_read_b64_tr_b16 v[56:57], v12 offset:16384
    ds_read_b64_tr_b16 v[58:59], v12 offset:18432
    ds_read_b64_tr_b16 v[60:61], v12 offset:24576
    ds_read_b64_tr_b16 v[62:63], v12 offset:26624
    ds_read_b64_tr_b16 v[64:65], v12 offset:32768
    ds_read_b64_tr_b16 v[66:67], v12 offset:34816
    ds_read_b64_tr_b16 v[68:69], v12 offset:40960
    ds_read_b64_tr_b16 v[70:71], v12 offset:43008
    ds_read_b64_tr_b16 v[72:73], v12 offset:49152
    ds_read_b64_tr_b16 v[74:75], v12 offset:51200
    ds_read_b64_tr_b16 v[76:77], v12 offset:57344
    ds_read_b64_tr_b16 v[78:79], v12 offset:59392
    s_waitcnt vmcnt(3)
    v_xor_b32 v112, v112, v4
    v_xor_b32 v114, v114, v4
    v_or_b32 v144, v112, v114
    s_waitcnt vmcnt(2)
    v_xor_b32 v116, v116, v4
    v_xor_b32 v118, v118, v4
    v_or3_b32 v144, v116, v118, v144
    s_waitcnt vmcnt(1)
    v_xor_b32 v120, v120, v4
    v_xor_b32 v122, v122, v4
    v_or3_b32 v144, v120, v122, v144
    s_waitcnt vmcnt(0)
    v_xor_b32 v124, v124, v4
    v_xor_b32 v126, v126, v4
    v_or3_b32 v144, v124, v126, v144
    v_and_b32 v144, s33, v144
    v_cmp_ne_u32 vcc, 0, v144
    s_cbranch_vccnz Rp_39_e
Ok_38:
    v_lshlrev_b32 v128, 20, v113
    v_lshlrev_b32 v132, 8, v115
    v_lshlrev_b32 v129, 20, v117
    v_lshlrev_b32 v133, 8, v119
    v_lshlrev_b32 v130, 20, v121
    v_lshlrev_b32 v134, 8, v123
    v_lshlrev_b32 v131, 20, v125
    v_lshlrev_b32 v135, 8, v127
    v_bfi_b32 v128, s44, v132, v128
    v_bfi_b32 v129, s44, v133, v129
    v_bfi_b32 v130, s44, v134, v130
    v_bfi_b32 v131, s44, v135, v131
    v_max_f32 v132, v128, v129
    v_max3_f32 v132, v132, v130, v131
    v_mov_b32 v133, v132
    s_nop 1
    v_permlane16_swap_b32 v132, v133
    v_max_f32 v132, v132, v133
    v_mov_b32 v133, v132
    s_nop 1
    v_permlane32_swap_b32 v132, v133
    v_max_f32 v132, v132, v133
    v_sub_f32 v128, v128, v132
    v_sub_f32 v129, v129, v132
    v_sub_f32 v130, v130, v132
    v_sub_f32 v131, v131, v132
    v_exp_f32 v128, v128
    v_exp_f32 v129, v129
    v_exp_f32 v130, v130
    v_exp_f32 v131, v131
    v_mul_f32 v112, v112, v128
    v_mul_f32 v113, v113, v128
    v_mul_f32 v114, v114, v128
    v_mul_f32 v115, v115, v128
    v_add_f32 v132, v128, v129
    v_add_f32 v133, v130, v131
    v_add_f32 v132, v132, v133
    v_fmac_f32 v112, v116, v129
    v_fmac_f32 v113, v117, v129
    v_fmac_f32 v114, v118, v129
    v_fmac_f32 v115, v119, v129
    v_mov_b32 v133, v132
    v_fmac_f32 v112, v120, v130
    v_fmac_f32 v113, v121, v130
    v_fmac_f32 v114, v122, v130
    v_fmac_f32 v115, v123, v130
    v_permlane16_swap_b32 v132, v133
    v_add_f32 v132, v132, v133
    v_mov_b32 v133, v132
    v_fmac_f32 v112, v124, v131
    v_fmac_f32 v113, v125, v131
    v_fmac_f32 v114, v126, v131
    v_fmac_f32 v115, v127, v131
    v_permlane32_swap_b32 v132, v133
    v_add_f32 v132, v132, v133
    v_permlane32_swap_b32 v112, v114
    v_permlane32_swap_b32 v113, v115
    v_add_f32 v112, v112, v114
    v_add_f32 v113, v113, v115
    v_rcp_f32 v132, v132
    s_nop 0
    v_permlane16_swap_b32 v112, v113
    v_add_f32 v112, v112, v113
    v_mul_f32 v112, v112, v132
    v_cvt_pk_bf16_f32 v112, v112, v112
    ds_write_b16 v161, v112 offset:7168
    s_waitcnt lgkmcnt(0)
    s_barrier
    ds_read_b128 v[16:19], v13 offset:7168
    ds_read_b128 v[20:23], v13 offset:7296
    ds_read_b128 v[24:27], v13 offset:7424
    ds_read_b128 v[28:31], v13 offset:7552
    s_waitcnt lgkmcnt(3)
    v_smfmac_f32_16x16x64_bf16 v[136:139], v[16:19], v[48:55], v9
    s_waitcnt lgkmcnt(2)
    v_smfmac_f32_16x16x64_bf16 v[136:139], v[20:23], v[56:63], v9
    s_waitcnt lgkmcnt(1)
    v_smfmac_f32_16x16x64_bf16 v[136:139], v[24:27], v[64:71], v9
    s_waitcnt lgkmcnt(0)
    v_smfmac_f32_16x16x64_bf16 v[136:139], v[28:31], v[72:79], v9
    s_nop 7
    v_add_f32 v136, v136, v137
    v_add_u32 v136, 0x800, v136
    v_bfi_b32 v136, s33, v4, v136
    s_mov_b32 exec_hi, 0
    global_store_dword v10, v136, s[58:59] sc1
    s_mov_b64 exec, -1
    s_barrier
    s_cmp_ge_u32 s14, 14
    s_cbranch_scc1 L_fin
    s_mul_i32 s43, s3, 14
    s_lshl_b32 s45, s14, 0
    s_add_u32 s43, s43, s45
    s_lshr_b32 s44, s43, 3
    s_and_b32 s43, s43, 7
    s_lshl_b32 s42, s44, 14
    s_lshl_b32 s45, s43, 8
    s_add_u32 s42, s42, s45
    s_add_u32 s42, s42, 1445888
    s_add_u32 s38, s28, s42
    s_addc_u32 s39, s29, 0
    s_add_u32 s40, s38, 8192
    s_addc_u32 s41, s39, 0
    s_add_u32 s56, s38, 229376
    s_addc_u32 s57, s39, 0
    s_add_u32 s100, s38, 237568
    s_addc_u32 s101, s39, 0
    s_lshl_b32 s42, s14, 10
    s_add_u32 s42, s42, 2134016
    s_add_u32 s58, s28, s42
    s_addc_u32 s59, s29, 0
    v_lshlrev_b32 v153, 11, v2
    v_lshl_add_u32 v153, v3, 4, v153
    v_lshlrev_b32 v154, 8, v2
    v_and_b32 v148, 4, v1
    v_lshl_add_u32 v154, v148, 5, v154
    v_and_b32 v148, 8, v1
    v_lshl_add_u32 v154, v148, 3, v154
    s_mul_i32 s42, s30, 14336
    s_lshl_b32 s45, s14, 10
    s_add_u32 s42, s42, s45
    s_add_u32 s42, s42, 1904640
    v_add_u32 v155, s42, v7
    s_add_u32 s98, s28, 114688
    s_addc_u32 s99, s29, 0
    v_add_u32 v156, 65536, v12
    v_and_b32 v148, 7, v1
    v_and_b32 v149, 1, v2
    v_lshl_add_u32 v148, v148, 1, v149
    v_lshrrev_b32 v149, 2, v148
    v_xor_b32 v149, v149, v148
    v_and_b32 v149, 2, v149
    v_mul_u32_u24 v149, 5, v149
    v_xor_b32 v148, v148, v149
    v_lshrrev_b32 v149, 5, v1
    v_lshl_add_u32 v148, v149, 7, v148
    v_bfe_u32 v149, v1, 3, 1
    v_mul_u32_u24 v149, 640, v149
    v_lshl_add_u32 v148, v148, 1, v149
    s_lshl_b32 s42, s3, 5
    v_add3_u32 v157, v148, v8, s42
    s_mov_b32 s44, 0xffff0000
    v_mov_b64 v[136:137], 0
    v_mov_b64 v[138:139], 0
    s_barrier
    global_load_dwordx4 v[128:131], v154, s[58:59] offset:0 sc1
    global_load_dwordx4 v[112:115], v153, s[38:39] offset:0 sc1
    global_load_dwordx4 v[116:119], v153, s[40:41] offset:0 sc1
    global_load_dwordx4 v[120:123], v153, s[56:57] offset:0 sc1
    global_load_dwordx4 v[124:127], v153, s[100:101] offset:0 sc1
    s_barrier
    ds_read_b64_tr_b16 v[48:49], v156 offset:0
    ds_read_b64_tr_b16 v[50:51], v156 offset:2048
    ds_read_b64_tr_b16 v[52:53], v156 offset:8192
    ds_read_b64_tr_b16 v[54:55], v156 offset:10240
    ds_read_b64_tr_b16 v[56:57], v156 offset:16384
    ds_read_b64_tr_b16 v[58:59], v156 offset:18432
    ds_read_b64_tr_b16 v[60:61], v156 offset:24576
    ds_read_b64_tr_b16 v[62:63], v156 offset:26624
    ds_read_b64_tr_b16 v[64:65], v156 offset:32768
    ds_read_b64_tr_b16 v[66:67], v156 offset:34816
    ds_read_b64_tr_b16 v[68:69], v156 offset:40960
    ds_read_b64_tr_b16 v[70:71], v156 offset:43008
    ds_read_b64_tr_b16 v[72:73], v156 offset:49152
    ds_read_b64_tr_b16 v[74:75], v156 offset:51200
    ds_read_b64_tr_b16 v[76:77], v156 offset:57344
    ds_read_b64_tr_b16 v[78:79], v156 offset:59392
    s_waitcnt vmcnt(3)
    v_xor_b32 v112, v112, v4
    v_xor_b32 v114, v114, v4
    v_or_b32 v144, v112, v114
    s_waitcnt vmcnt(2)
    v_xor_b32 v116, v116, v4
    v_xor_b32 v118, v118, v4
    v_or3_b32 v144, v116, v118, v144
    s_waitcnt vmcnt(1)
    v_xor_b32 v120, v120, v4
    v_xor_b32 v122, v122, v4
    v_or3_b32 v144, v120, v122, v144
    s_waitcnt vmcnt(0)
    v_xor_b32 v124, v124, v4
    v_xor_b32 v126, v126, v4
    v_or3_b32 v144, v124, v126, v144
    v_and_b32 v144, s33, v144
    v_bitop3_b32 v144, v129, v5, v144 bitop3:0xbe
    v_bitop3_b32 v144, v131, v5, v144 bitop3:0xbe
    v_cmp_ne_u32 vcc, 0, v144
    s_cbranch_vccnz Rp_41_e
Ok_40:
    v_permlane32_swap_b32 v128, v130
    v_add_f32 v80, v112, v116
    v_lshlrev_b32 v84, 16, v113
    v_add_f32 v128, v128, v130
    v_lshlrev_b32 v92, 16, v117
    v_add_f32 v84, v84, v92
    v_add_f32_dpp v128, v128, v128 row_half_mirror row_mask:0xf bank_mask:0xf
    v_and_b32 v88, s44, v113
    v_and_b32 v93, s44, v117
    v_mov_b32 v129, v128
    v_add_f32 v88, v88, v93
    v_add_f32 v81, v114, v118
    v_permlane16_swap_b32 v128, v129
    v_lshlrev_b32 v85, 16, v115
    v_lshlrev_b32 v92, 16, v119
    v_add_f32 v128, v128, v129
    v_add_f32 v85, v85, v92
    v_and_b32 v89, s44, v115
    v_mov_b32 v130, v128
    v_and_b32 v93, s44, v119
    v_add_f32 v89, v89, v93
    v_permlane32_swap_b32 v128, v130
    v_add_f32 v82, v120, v124
    v_lshlrev_b32 v86, 16, v121
    v_mul_f32 v128, 0x3a800000, v128
    v_lshlrev_b32 v92, 16, v125
    v_add_f32 v86, v86, v92
    v_mul_f32 v130, 0x3a800000, v130
    v_and_b32 v90, s44, v121
    v_and_b32 v93, s44, v125
    v_fma_f32 v130, -v128, v128, v130
    v_add_f32 v90, v90, v93
    v_add_f32 v83, v122, v126
    v_max_f32 v130, 0, v130
    v_lshlrev_b32 v87, 16, v123
    v_lshlrev_b32 v92, 16, v127
    v_add_f32 v130, 0x3727c5ac, v130
    v_add_f32 v87, v87, v92
    v_and_b32 v91, s44, v123
    v_rsq_f32 v130, v130
    v_and_b32 v93, s44, v127
    v_add_f32 v91, v91, v93
    v_fma_f32 v80, -v128, v84, v80
    v_fma_f32 v81, -v128, v85, v81
    v_fma_f32 v82, -v128, v86, v82
    v_fma_f32 v83, -v128, v87, v83
    v_fma_f32 v80, v80, v130, v88
    v_fma_f32 v81, v81, v130, v89
    v_fma_f32 v82, v82, v130, v90
    v_fma_f32 v83, v83, v130, v91
    s_nop 0
    v_permlane32_swap_b32 v80, v82
    v_permlane32_swap_b32 v81, v83
    v_add_f32 v80, v80, v82
    v_add_f32 v81, v81, v83
    s_nop 1
    v_permlane16_swap_b32 v80, v81
    v_add_f32 v80, v80, v81
    v_max_f32 v80, 0, v80
    v_cvt_pk_bf16_f32 v80, v80, v80
    ds_write_b16 v157, v80 offset:4608
    s_waitcnt lgkmcnt(0)
    s_barrier
    ds_read_b128 v[16:19], v13 offset:4608
    ds_read_b128 v[20:23], v13 offset:4736
    ds_read_b128 v[24:27], v13 offset:4864
    ds_read_b128 v[28:31], v13 offset:4992
    s_waitcnt lgkmcnt(3)
    v_smfmac_f32_16x16x64_bf16 v[136:139], v[16:19], v[48:55], v9
    s_waitcnt lgkmcnt(2)
    v_smfmac_f32_16x16x64_bf16 v[136:139], v[20:23], v[56:63], v9
    s_waitcnt lgkmcnt(1)
    v_smfmac_f32_16x16x64_bf16 v[136:139], v[24:27], v[64:71], v9
    s_waitcnt lgkmcnt(0)
    v_smfmac_f32_16x16x64_bf16 v[136:139], v[28:31], v[72:79], v9
    s_nop 7
    v_add_f32 v136, v136, v137
    v_add_u32 v136, 0x800, v136
    v_bfi_b32 v136, s33, v4, v136
    s_mov_b32 exec_hi, 0
    global_store_dword v155, v136, s[98:99]
    global_store_dword v155, v136, s[28:29] sc1
    s_mov_b64 exec, -1
L_fin:
L_end:
    s_endpgm
Sp_15_r:
    s_sub_u32 s34, s34, 1
    s_cbranch_scc0 Sp_15
    s_mov_b32 s34, 0
    s_branch So_16
Sp_17_r:
    s_sleep 1
    s_sub_u32 s34, s34, 1
    s_cbranch_scc0 Sp_17
    s_mov_b32 s34, 0
    s_branch So_18
Sp_19_r:
    s_sleep 1
    s_sub_u32 s34, s34, 1
    s_cbranch_scc0 Sp_19
    s_mov_b32 s34, 0
    s_branch So_20
Rp_23_e:
Rp_23:
    s_mov_b64 exec, vcc
    global_load_dwordx4 v[112:115], v152, s[38:39] offset:0 sc1
    global_load_dwordx4 v[116:119], v152, s[38:39] offset:1024 sc1
    global_load_dwordx4 v[120:123], v152, s[38:39] offset:2048 sc1
    global_load_dwordx4 v[124:127], v152, s[38:39] offset:3072 sc1
    s_waitcnt vmcnt(0)
    v_xor_b32 v112, v112, v4
    v_xor_b32 v113, v113, v4
    v_xor_b32 v114, v114, v4
    v_xor_b32 v115, v115, v4
    v_xor_b32 v116, v116, v4
    v_xor_b32 v117, v117, v4
    v_xor_b32 v118, v118, v4
    v_xor_b32 v119, v119, v4
    v_xor_b32 v120, v120, v4
    v_xor_b32 v121, v121, v4
    v_xor_b32 v122, v122, v4
    v_xor_b32 v123, v123, v4
    v_xor_b32 v124, v124, v4
    v_xor_b32 v125, v125, v4
    v_xor_b32 v126, v126, v4
    v_xor_b32 v127, v127, v4
    v_or_b32 v144, v112, v113
    v_or3_b32 v144, v114, v115, v144
    v_or3_b32 v144, v116, v117, v144
    v_or3_b32 v144, v118, v119, v144
    v_or3_b32 v144, v120, v121, v144
    v_or3_b32 v144, v122, v123, v144
    v_or3_b32 v144, v124, v125, v144
    v_or3_b32 v144, v126, v127, v144
    v_and_b32 v144, s33, v144
    v_cmp_ne_u32 vcc, 0, v144
    s_cbranch_vccz Ok_22_dn
    s_add_u32 s15, s15, 1
    s_and_b32 s45, s15, 31
    s_cbranch_scc1 Rp_23_nf
    buffer_wbl2 sc1
    s_waitcnt vmcnt(0)
    buffer_inv sc1
    s_waitcnt vmcnt(0)
Rp_23_nf:
    s_sub_u32 s34, s34, 1
    s_cbranch_scc0 Rp_23
    s_mov_b32 s34, 0
Ok_22_dn:
    s_mov_b64 exec, -1
    s_nop 1
    s_branch Ok_22
Sp_24_r:
    s_sleep 1
    s_sub_u32 s34, s34, 1
    s_cbranch_scc0 Sp_24
    s_mov_b32 s34, 0
    s_branch So_25
Rp_27_e:
    global_load_dwordx4 v[112:115], v153, s[98:99] offset:0 sc1
    global_load_dwordx4 v[116:119], v153, s[98:99] offset:1024 sc1
Rp_27:
    s_mov_b64 exec, vcc
    global_load_dwordx4 v[80:83], v152, s[38:39] offset:0 sc1
    global_load_dwordx4 v[84:87], v152, s[40:41] offset:0 sc1
    global_load_dwordx4 v[88:91], v152, s[56:57] offset:0 sc1
    s_waitcnt vmcnt(0)
    v_xor_b32 v80, v80, v4
    v_xor_b32 v81, v81, v4
    v_xor_b32 v82, v82, v4
    v_xor_b32 v83, v83, v4
    v_xor_b32 v84, v84, v4
    v_xor_b32 v85, v85, v4
    v_xor_b32 v86, v86, v4
    v_xor_b32 v87, v87, v4
    v_xor_b32 v88, v88, v4
    v_xor_b32 v89, v89, v4
    v_xor_b32 v90, v90, v4
    v_xor_b32 v91, v91, v4
    v_or_b32 v144, v80, v81
    v_or3_b32 v144, v82, v83, v144
    v_or3_b32 v144, v84, v85, v144
    v_or3_b32 v144, v86, v87, v144
    v_or3_b32 v144, v88, v89, v144
    v_or3_b32 v144, v90, v91, v144
    v_and_b32 v144, s33, v144
    v_cmp_ne_u32 vcc, 0, v144
    s_cbranch_vccz Ok_26_dn
    s_add_u32 s15, s15, 1
    s_and_b32 s45, s15, 31
    s_cbranch_scc1 Rp_27_nf
    buffer_wbl2 sc1
    s_waitcnt vmcnt(0)
    buffer_inv sc1
    s_waitcnt vmcnt(0)
Rp_27_nf:
    s_sub_u32 s34, s34, 1
    s_cbranch_scc0 Rp_27
    s_mov_b32 s34, 0
Ok_26_dn:
    s_mov_b64 exec, -1
    s_nop 1
    s_branch Ok_26
Rp_29_e:
Rp_29:
    s_mov_b64 exec, vcc
    global_load_dwordx4 v[112:115], v153, s[98:99] offset:0 sc1
    global_load_dwordx4 v[116:119], v153, s[98:99] offset:1024 sc1
    s_waitcnt vmcnt(0)
    v_xor_b32 v112, v112, v4
    v_xor_b32 v113, v113, v4
    v_xor_b32 v114, v114, v4
    v_xor_b32 v115, v115, v4
    v_xor_b32 v116, v116, v4
    v_xor_b32 v117, v117, v4
    v_xor_b32 v118, v118, v4
    v_xor_b32 v119, v119, v4
    v_or_b32 v144, v112, v113
    v_or3_b32 v144, v114, v115, v144
    v_or3_b32 v144, v116, v117, v144
    v_or3_b32 v144, v118, v119, v144
    v_and_b32 v144, s33, v144
    v_cmp_ne_u32 vcc, 0, v144
    s_cbranch_vccz Ok_28_dn
    s_add_u32 s15, s15, 1
    s_and_b32 s45, s15, 31
    s_cbranch_scc1 Rp_29_nf
    buffer_wbl2 sc1
    s_waitcnt vmcnt(0)
    buffer_inv sc1
    s_waitcnt vmcnt(0)
Rp_29_nf:
    s_sub_u32 s34, s34, 1
    s_cbranch_scc0 Rp_29
    s_mov_b32 s34, 0
Ok_28_dn:
    s_mov_b64 exec, -1
    s_nop 1
    s_branch Ok_28
Rp_31_e:
Rp_31:
    s_mov_b64 exec, vcc
    global_load_dwordx4 v[80:83], v152, s[38:39] offset:0 sc1
    global_load_dwordx4 v[84:87], v152, s[58:59] offset:0 sc1
    global_load_dwordx4 v[112:115], v153, s[98:99] offset:0 sc1
    global_load_dwordx4 v[116:119], v153, s[98:99] offset:1024 sc1
    s_waitcnt vmcnt(0)
    v_xor_b32 v80, v80, v4
    v_xor_b32 v81, v81, v4
    v_xor_b32 v82, v82, v4
    v_xor_b32 v83, v83, v4
    v_xor_b32 v84, v84, v4
    v_xor_b32 v85, v85, v4
    v_xor_b32 v86, v86, v4
    v_xor_b32 v87, v87, v4
    v_xor_b32 v112, v112, v4
    v_xor_b32 v113, v113, v4
    v_xor_b32 v114, v114, v4
    v_xor_b32 v115, v115, v4
    v_xor_b32 v116, v116, v4
    v_xor_b32 v117, v117, v4
    v_xor_b32 v118, v118, v4
    v_xor_b32 v119, v119, v4
    v_or_b32 v144, v80, v81
    v_or3_b32 v144, v82, v83, v144
    v_or3_b32 v144, v84, v85, v144
    v_or3_b32 v144, v86, v87, v144
    v_or3_b32 v144, v112, v113, v144
    v_or3_b32 v144, v114, v115, v144
    v_or3_b32 v144, v116, v117, v144
    v_or3_b32 v144, v118, v119, v144
    v_and_b32 v144, s33, v144
    v_cmp_ne_u32 vcc, 0, v144
    s_cbranch_vccz Ok_30_dn
    s_add_u32 s15, s15, 1
    s_and_b32 s45, s15, 31
    s_cbranch_scc1 Rp_31_nf
    buffer_wbl2 sc1
    s_waitcnt vmcnt(0)
    buffer_inv sc1
    s_waitcnt vmcnt(0)
Rp_31_nf:
    s_sub_u32 s34, s34, 1
    s_cbranch_scc0 Rp_31
    s_mov_b32 s34, 0
Ok_30_dn:
    s_mov_b64 exec, -1
    s_nop 1
    s_branch Ok_30
Rp_33_e:
Rp_33:
    s_mov_b64 exec, vcc
    global_load_dwordx4 v[112:115], v160, s[100:101] offset:0 sc1
    global_load_dwordx4 v[116:119], v160, s[100:101] offset:1024 sc1
    s_waitcnt vmcnt(0)
    v_xor_b32 v112, v112, v4
    v_xor_b32 v113, v113, v4
    v_xor_b32 v114, v114, v4
    v_xor_b32 v115, v115, v4
    v_xor_b32 v116, v116, v4
    v_xor_b32 v117, v117, v4
    v_xor_b32 v118, v118, v4
    v_xor_b32 v119, v119, v4
    v_or_b32 v144, v112, v113
    v_or3_b32 v144, v114, v115, v144
    v_or3_b32 v144, v116, v117, v144
    v_or3_b32 v144, v118, v119, v144
    v_and_b32 v144, s33, v144
    v_cmp_ne_u32 vcc, 0, v144
    s_cbranch_vccz Ok_32_dn
    s_add_u32 s15, s15, 1
    s_and_b32 s45, s15, 31
    s_cbranch_scc1 Rp_33_nf
    buffer_wbl2 sc1
    s_waitcnt vmcnt(0)
    buffer_inv sc1
    s_waitcnt vmcnt(0)
Rp_33_nf:
    s_sub_u32 s34, s34, 1
    s_cbranch_scc0 Rp_33
    s_mov_b32 s34, 0
Ok_32_dn:
    s_mov_b64 exec, -1
    s_nop 1
    s_branch Ok_32
L_f6b:
    v_pk_add_f32 v[128:129], v[120:121], v[124:125]
    v_pk_add_f32 v[130:131], v[122:123], v[126:127]
    s_branch L_f6c
Rp_35_e:
Rp_35:
    s_mov_b64 exec, vcc
    global_load_dwordx4 v[112:115], v153, s[38:39] offset:0 sc1
    global_load_dwordx4 v[116:119], v153, s[38:39] offset:1024 sc1
    global_load_dwordx4 v[120:123], v153, s[38:39] offset:2048 sc1
    global_load_dwordx4 v[124:127], v153, s[38:39] offset:3072 sc1
    s_waitcnt vmcnt(0)
    v_xor_b32 v112, v112, v4
    v_xor_b32 v113, v113, v4
    v_xor_b32 v114, v114, v4
    v_xor_b32 v115, v115, v4
    v_xor_b32 v116, v116, v4
    v_xor_b32 v117, v117, v4
    v_xor_b32 v118, v118, v4
    v_xor_b32 v119, v119, v4
    v_xor_b32 v120, v120, v4
    v_xor_b32 v121, v121, v4
    v_xor_b32 v122, v122, v4
    v_xor_b32 v123, v123, v4
    v_xor_b32 v124, v124, v4
    v_xor_b32 v125, v125, v4
    v_xor_b32 v126, v126, v4
    v_xor_b32 v127, v127, v4
    v_or_b32 v144, v112, v113
    v_or3_b32 v144, v114, v115, v144
    v_or3_b32 v144, v116, v117, v144
    v_or3_b32 v144, v118, v119, v144
    v_or3_b32 v144, v120, v121, v144
    v_or3_b32 v144, v122, v123, v144
    v_or3_b32 v144, v124, v125, v144
    v_or3_b32 v144, v126, v127, v144
    v_and_b32 v144, s33, v144
    v_cmp_ne_u32 vcc, 0, v144
    s_cbranch_vccz Ok_34_dn
    s_add_u32 s15, s15, 1
    s_and_b32 s45, s15, 31
    s_cbranch_scc1 Rp_35_nf
    buffer_wbl2 sc1
    s_waitcnt vmcnt(0)
    buffer_inv sc1
    s_waitcnt vmcnt(0)
Rp_35_nf:
    s_sub_u32 s34, s34, 1
    s_cbranch_scc0 Rp_35
    s_mov_b32 s34, 0
Ok_34_dn:
    s_mov_b64 exec, -1
    s_nop 1
    s_branch Ok_34
Sp_36_r:
    s_sleep 1
    s_sub_u32 s34, s34, 1
    s_cbranch_scc0 Sp_36
    s_mov_b32 s34, 0
    s_branch So_37
Rp_39_e:
    s_nop 1
    v_or_b32_dpp v144, v144, v144 quad_perm:[1,0,3,2] row_mask:0xf bank_mask:0xf
    s_nop 1
    v_or_b32_dpp v144, v144, v144 quad_perm:[2,3,0,1] row_mask:0xf bank_mask:0xf
    s_nop 1
    v_or_b32_dpp v144, v144, v144 row_half_mirror row_mask:0xf bank_mask:0xf
    v_cmp_ne_u32 vcc, 0, v144
Rp_39:
    s_nop 0
    s_mov_b64 exec, vcc
    global_load_dwordx4 v[112:115], v160, s[56:57] offset:0 sc1
    global_load_dwordx4 v[116:119], v160, s[56:57] offset:1024 sc1
    global_load_dwordx4 v[120:123], v160, s[56:57] offset:2048 sc1
    global_load_dwordx4 v[124:127], v160, s[56:57] offset:3072 sc1
    s_waitcnt vmcnt(0)
    v_xor_b32 v112, v112, v4
    v_xor_b32 v114, v114, v4
    v_xor_b32 v116, v116, v4
    v_xor_b32 v118, v118, v4
    v_xor_b32 v120, v120, v4
    v_xor_b32 v122, v122, v4
    v_xor_b32 v124, v124, v4
    v_xor_b32 v126, v126, v4
    v_or_b32 v144, v112, v114
    v_or3_b32 v144, v116, v118, v144
    v_or3_b32 v144, v120, v122, v144
    v_or3_b32 v144, v124, v126, v144
    v_and_b32 v144, s33, v144
    s_nop 1
    v_or_b32_dpp v144, v144, v144 quad_perm:[1,0,3,2] row_mask:0xf bank_mask:0xf
    s_nop 1
    v_or_b32_dpp v144, v144, v144 quad_perm:[2,3,0,1] row_mask:0xf bank_mask:0xf
    s_nop 1
    v_or_b32_dpp v144, v144, v144 row_half_mirror row_mask:0xf bank_mask:0xf
    v_cmp_ne_u32 vcc, 0, v144
    s_cbranch_vccz Ok_38_dn
    s_add_u32 s15, s15, 1
    s_and_b32 s45, s15, 31
    s_cbranch_scc1 Rp_39_nf
    buffer_wbl2 sc1
    s_waitcnt vmcnt(0)
    buffer_inv sc1
    s_waitcnt vmcnt(0)
Rp_39_nf:
    s_sub_u32 s34, s34, 1
    s_cbranch_scc0 Rp_39
    s_mov_b32 s34, 0
Ok_38_dn:
    s_mov_b64 exec, -1
    s_nop 1
    s_branch Ok_38
Rp_41_e:
    s_nop 1
    v_or_b32_dpp v144, v144, v144 quad_perm:[1,0,3,2] row_mask:0xf bank_mask:0xf
    s_nop 1
    v_or_b32_dpp v144, v144, v144 quad_perm:[2,3,0,1] row_mask:0xf bank_mask:0xf
    s_nop 1
    v_or_b32_dpp v144, v144, v144 row_half_mirror row_mask:0xf bank_mask:0xf
    v_cmp_ne_u32 vcc, 0, v144
Rp_41:
    s_nop 0
    s_mov_b64 exec, vcc
    global_load_dwordx4 v[128:131], v154, s[58:59] offset:0 sc1
    global_load_dwordx4 v[112:115], v153, s[38:39] offset:0 sc1
    global_load_dwordx4 v[116:119], v153, s[40:41] offset:0 sc1
    global_load_dwordx4 v[120:123], v153, s[56:57] offset:0 sc1
    global_load_dwordx4 v[124:127], v153, s[100:101] offset:0 sc1
    s_waitcnt vmcnt(0)
    v_xor_b32 v112, v112, v4
    v_xor_b32 v114, v114, v4
    v_xor_b32 v116, v116, v4
    v_xor_b32 v118, v118, v4
    v_xor_b32 v120, v120, v4
    v_xor_b32 v122, v122, v4
    v_xor_b32 v124, v124, v4
    v_xor_b32 v126, v126, v4
    v_or_b32 v144, v112, v114
    v_or3_b32 v144, v116, v118, v144
    v_or3_b32 v144, v120, v122, v144
    v_or3_b32 v144, v124, v126, v144
    v_and_b32 v144, s33, v144
    v_bitop3_b32 v144, v129, v5, v144 bitop3:0xbe
    v_bitop3_b32 v144, v131, v5, v144 bitop3:0xbe
    s_nop 1
    v_or_b32_dpp v144, v144, v144 quad_perm:[1,0,3,2] row_mask:0xf bank_mask:0xf
    s_nop 1
    v_or_b32_dpp v144, v144, v144 quad_perm:[2,3,0,1] row_mask:0xf bank_mask:0xf
    s_nop 1
    v_or_b32_dpp v144, v144, v144 row_half_mirror row_mask:0xf bank_mask:0xf
    v_cmp_ne_u32 vcc, 0, v144
    s_cbranch_vccz Ok_40_dn
    s_add_u32 s15, s15, 1
    s_and_b32 s45, s15, 31
    s_cbranch_scc1 Rp_41_nf
    buffer_wbl2 sc1
    s_waitcnt vmcnt(0)
    buffer_inv sc1
    s_waitcnt vmcnt(0)
Rp_41_nf:
    s_sub_u32 s34, s34, 1
    s_cbranch_scc0 Rp_41
    s_mov_b32 s34, 0
Ok_40_dn:
    s_mov_b64 exec, -1
    s_nop 1
    s_branch Ok_40
L_codeend:
.section .rodata,"a"
.p2align 6
.amdhsa_kernel adaLN_cond__sliding_block_cached__dense_activation_relu__decode_kernel
  .amdhsa_next_free_vgpr 168
  .amdhsa_next_free_sgpr 102
  .amdhsa_accum_offset 168
  .amdhsa_group_segment_fixed_size 0
  .amdhsa_kernarg_size 104
  .amdhsa_user_sgpr_count 2
  .amdhsa_user_sgpr_kernarg_segment_ptr 1
  .amdhsa_system_sgpr_workgroup_id_x 1
  .amdhsa_float_denorm_mode_32 3
.end_amdhsa_kernel
```
